```python
import torch

def _softmax(x, axis=-1):
    return torch.softmax(x, dim=axis)
def _gelu(x):
    return torch.nn.functional.gelu(x, approximate="tanh")
def _silu(x):
    return torch.nn.functional.silu(x)
def _sigmoid(x):
    return torch.sigmoid(x)
def _layernorm(x, axis=-1, eps=1e-5):
    m = x.mean(dim=axis, keepdim=True)
    v = x.var(dim=axis, keepdim=True, unbiased=False)
    return (x - m) / torch.sqrt(v + eps)
def _scatter_add(tgt, idx, src, axis=0):
    return tgt.clone().index_add_(axis, idx, src)
def _segment_sum(src, seg, n):
    out = torch.zeros((n,) + src.shape[1:], dtype=src.dtype)
    return out.index_add_(0, seg, src)
def _pad(x, pw):
    flat = tuple(v for pair in reversed(pw) for v in pair)
    return torch.nn.functional.pad(x, flat)

kernel_name = 'standalone__mha_block_cached__near_ridge'

def setup_inputs():

    _w = (lambda a: (lambda t: t.to(torch.bfloat16) if t.is_floating_point() else t)(torch.as_tensor(a)))
    B, Sq, D = 8, 144, 640
    H, Sk, Dh = 32, 1024, 128
    return {
        "x": _w((lambda *s: torch.randn(*s, dtype=torch.bfloat16) * 0.8)(B, Sq, D)),
        "k_cache": _w((lambda *s: torch.randn(*s, dtype=torch.bfloat16) * 0.8)(B, H, Sk, Dh)),
        "v_cache": _w((lambda *s: torch.randn(*s, dtype=torch.bfloat16) * 0.05)(B, H, Sk, Dh)),
        "wq": _w((lambda *s: torch.randn(*s, dtype=torch.bfloat16) * 0.8)(D, H * Dh) * (D ** -0.5)),
        "wo": _w((lambda *s: torch.randn(*s, dtype=torch.bfloat16) * 0.05)(H * Dh, D) * ((H * Dh) ** -0.5)),
    }

def reference(x, k_cache, v_cache, wq, wo):
    B, Sq, D = x.shape
    H, Dh = 32, 128
    q = (lambda x, *d: x.permute(*d))((x @ wq).reshape(B, Sq, H, Dh), 0, 2, 1, 3)
    scores = torch.einsum("bhqd,bhkd->bhqk", q, k_cache) * (Dh ** -0.5)
    p = _softmax(scores, axis=-1)
    o = torch.einsum("bhqk,bhkd->bhqd", p, v_cache)
    return (lambda x, *d: x.permute(*d))(o, 0, 2, 1, 3).reshape(B, Sq, H * Dh) @ wo
```

```asm
; @launch grid=(256,1,1) block=(256,1,1) lds=163840
.amdgcn_target "amdgcn-amd-amdhsa--gfx950"
.text
.globl standalone__mha_block_cached__near_ridge_kernel
.p2align 8
.type standalone__mha_block_cached__near_ridge_kernel,@function
standalone__mha_block_cached__near_ridge_kernel:
    s_cmp_ge_u32 s2, 256
    s_cbranch_scc1 L_end
    s_load_dwordx8 s[4:11], s[0:1], 0
    s_load_dwordx8 s[12:19], s[0:1], 32
    v_lshrrev_b32 v1, 6, v0
    v_and_b32 v0, 63, v0
    v_readfirstlane_b32 s3, v1
    s_lshr_b32 s64, s2, 3
    s_bfe_u32 s65, s2, 0x20001
    s_and_b32 s66, s2, 1
    s_and_b32 s57, s64, 3
    s_lshl2_add_u32 s66, s66, s57
    s_lshr_b32 s53, s2, 5
    s_mov_b32 s57, s53
    s_lshl3_add_u32 s52, s65, s66
    s_cmp_lg_u32 s3, 3
    s_cbranch_scc1 L_compute
    v_lshrrev_b32 v1, 4, v0
    v_and_b32 v2, 15, v0
    v_lshrrev_b32 v3, 3, v0
    v_and_b32 v16, 7, v0
    v_or_b32 v17, 0, v1
    v_lshlrev_b32 v17, 1, v17
    v_xor_b32 v17, v17, v2
    v_lshlrev_b32 v17, 4, v17
    v_lshl_add_u32 v17, v1, 13, v17
    v_add_u32 v20, 0, v17
    v_add_u32 v21, 31744, v17
    v_or_b32 v17, 4, v1
    v_lshlrev_b32 v17, 1, v17
    v_xor_b32 v17, v17, v2
    v_lshlrev_b32 v17, 4, v17
    v_lshl_add_u32 v17, v1, 13, v17
    v_add_u32 v22, 63488, v17
    v_add_u32 v23, 95232, v17
    v_mul_u32_u24 v18, 1280, v3
    v_or_b32 v17, 0, v1
    v_xor_b32 v17, v17, v16
    v_lshl_add_u32 v17, v17, 4, v18
    v_add_u32 v24, 0, v17
    v_add_u32 v26, 18432, v17
    v_or_b32 v17, 4, v1
    v_xor_b32 v17, v17, v16
    v_lshl_add_u32 v17, v17, 4, v18
    v_add_u32 v25, 9216, v17
    v_add_u32 v27, 27648, v17
    s_add_u32 s72, s66, s57
    s_mul_i32 s55, s72, 0x5556
    s_lshr_b32 s55, s55, 16
    s_mul_i32 s55, s55, 3
    s_sub_u32 s72, s72, s55
    s_mul_i32 s72, s72, 7
    s_lshr_b32 s72, s72, 1
    s_mov_b32 s61, 58368
    s_mul_i32 s56, s53, 184320
    s_lshl_b32 s57, s52, 8
    s_waitcnt lgkmcnt(0)
    s_add_u32 s32, s10, s57
    s_addc_u32 s33, s11, 0
    s_mov_b32 s35, 0x20000
    s_sub_u32 s34, 5242880, s57
    s_add_u32 s28, s4, s56
    s_addc_u32 s29, s5, 0
    s_mov_b32 s30, 184320
    s_mov_b32 s31, 0x20000
    s_getpc_b64 s[58:59]
L_pcq:
    s_add_u32 s58, s58, L_ldq_go-L_pcq
    s_addc_u32 s59, s59, 0
L_qstep:
    s_lshl_b32 s74, s72, 19
    s_lshl_b32 s73, s72, 7
    s_add_u32 m0, s61, 0
    s_add_u32 s55, s74, 0
    buffer_load_dwordx4 v20, s[32:35], s55 offen offset:0  lds
    buffer_load_dwordx4 v21, s[32:35], s55 offen offset:1024  lds
    buffer_load_dwordx4 v22, s[32:35], s55 offen offset:2048  lds
    buffer_load_dwordx4 v23, s[32:35], s55 offen offset:3072  lds
    s_add_u32 m0, s61, 16384
    s_add_u32 s55, s73, 0
    buffer_load_dwordx4 v24, s[28:31], s55 offen offset:0  lds
    buffer_load_dwordx4 v25, s[28:31], s55 offen offset:1024  lds
    buffer_load_dwordx4 v26, s[28:31], s55 offen offset:2048  lds
    buffer_load_dwordx4 v27, s[28:31], s55 offen offset:3072  lds
    s_add_u32 m0, s61, 4096
    s_add_u32 s55, s74, 131072
    buffer_load_dwordx4 v20, s[32:35], s55 offen offset:0  lds
    buffer_load_dwordx4 v21, s[32:35], s55 offen offset:1024  lds
    buffer_load_dwordx4 v22, s[32:35], s55 offen offset:2048  lds
    buffer_load_dwordx4 v23, s[32:35], s55 offen offset:3072  lds
    s_add_u32 m0, s61, 20480
    s_add_u32 s55, s73, 40960
    buffer_load_dwordx4 v24, s[28:31], s55 offen offset:0  lds
    buffer_load_dwordx4 v25, s[28:31], s55 offen offset:1024  lds
    buffer_load_dwordx4 v26, s[28:31], s55 offen offset:2048  lds
    buffer_load_dwordx4 v27, s[28:31], s55 offen offset:3072  lds
    s_add_u32 m0, s61, 8192
    s_add_u32 s55, s74, 262144
    buffer_load_dwordx4 v20, s[32:35], s55 offen offset:0  lds
    buffer_load_dwordx4 v21, s[32:35], s55 offen offset:1024  lds
    buffer_load_dwordx4 v22, s[32:35], s55 offen offset:2048  lds
    buffer_load_dwordx4 v23, s[32:35], s55 offen offset:3072  lds
    s_add_u32 m0, s61, 24576
    s_add_u32 s55, s73, 81920
    buffer_load_dwordx4 v24, s[28:31], s55 offen offset:0  lds
    buffer_load_dwordx4 v25, s[28:31], s55 offen offset:1024  lds
    buffer_load_dwordx4 v26, s[28:31], s55 offen offset:2048  lds
    buffer_load_dwordx4 v27, s[28:31], s55 offen offset:3072  lds
    s_add_u32 m0, s61, 12288
    s_add_u32 s55, s74, 393216
    buffer_load_dwordx4 v20, s[32:35], s55 offen offset:0  lds
    buffer_load_dwordx4 v21, s[32:35], s55 offen offset:1024  lds
    buffer_load_dwordx4 v22, s[32:35], s55 offen offset:2048  lds
    buffer_load_dwordx4 v23, s[32:35], s55 offen offset:3072  lds
    s_add_u32 m0, s61, 28672
    s_add_u32 s55, s73, 122880
    buffer_load_dwordx4 v24, s[28:31], s55 offen offset:0  lds
    buffer_load_dwordx4 v25, s[28:31], s55 offen offset:1024  lds
    buffer_load_dwordx4 v26, s[28:31], s55 offen offset:2048  lds
    buffer_load_dwordx4 v27, s[28:31], s55 offen offset:3072  lds
    s_add_u32 m0, s61, 32768
    s_add_u32 s55, s73, 163840
    buffer_load_dwordx4 v24, s[28:31], s55 offen offset:0  lds
    buffer_load_dwordx4 v25, s[28:31], s55 offen offset:1024  lds
    s_add_u32 s72, s72, 1
    s_cmp_eq_u32 s72, 10
    s_cselect_b32 s72, 0, s72
    s_add_u32 s61, s61, 34816
    s_cmp_eq_u32 s61, 162816
    s_cselect_b32 s61, 58368, s61
    s_setpc_b64 s[58:59]
L_ldq_go:
    v_or_b32 v17, 0, v1
    v_xor_b32 v17, v17, v2
    v_lshlrev_b32 v17, 4, v17
    v_lshl_add_u32 v17, v1, 13, v17
    v_add_u32 v28, 0, v17
    v_or_b32 v17, 4, v1
    v_xor_b32 v17, v17, v2
    v_lshlrev_b32 v17, 4, v17
    v_lshl_add_u32 v17, v1, 13, v17
    v_add_u32 v29, 31744, v17
    v_or_b32 v17, 8, v1
    v_xor_b32 v17, v17, v2
    v_lshlrev_b32 v17, 4, v17
    v_lshl_add_u32 v17, v1, 13, v17
    v_add_u32 v30, 63488, v17
    v_or_b32 v17, 12, v1
    v_xor_b32 v17, v17, v2
    v_lshlrev_b32 v17, 4, v17
    v_lshl_add_u32 v17, v1, 13, v17
    v_add_u32 v31, 95232, v17
    v_or_b32 v17, 0, v1
    v_lshlrev_b32 v17, 1, v17
    v_xor_b32 v17, v17, v2
    v_lshlrev_b32 v17, 4, v17
    v_lshl_add_u32 v17, v1, 13, v17
    v_add_u32 v32, 0, v17
    v_add_u32 v34, 63488, v17
    v_or_b32 v17, 4, v1
    v_lshlrev_b32 v17, 1, v17
    v_xor_b32 v17, v17, v2
    v_lshlrev_b32 v17, 4, v17
    v_lshl_add_u32 v17, v1, 13, v17
    v_add_u32 v33, 31744, v17
    v_add_u32 v35, 95232, v17
    s_lshl_b32 s54, s53, 5
    s_add_u32 s54, s54, s52
    s_lshl_b32 s55, s54, 18
    s_add_u32 s20, s6, s55
    s_addc_u32 s21, s7, 0
    s_mov_b32 s22, 262144
    s_mov_b32 s23, 0x20000
    s_add_u32 s24, s8, s55
    s_addc_u32 s25, s9, 0
    s_mov_b32 s26, 262144
    s_mov_b32 s27, 0x20000
    s_mov_b32 s36, s12
    s_mov_b32 s37, s13
    s_mov_b32 s38, 5242880
    s_mov_b32 s39, 0x20000
    s_mov_b32 s44, s18
    s_mov_b32 s45, s19
    s_mov_b32 s46, 268435456
    s_mov_b32 s47, 0x20000
    s_mov_b32 s40, s16
    s_mov_b32 s41, s17
    s_mov_b32 s42, 256
    s_mov_b32 s43, 0x20000
    s_mov_b32 s19, 0x76543210
    s_cmp_eq_u32 s66, 1
    s_cselect_b32 s19, 0x7654321, s19
    s_cmp_eq_u32 s66, 2
    s_cselect_b32 s19, 0x10765432, s19
    s_cmp_eq_u32 s66, 3
    s_cselect_b32 s19, 0x21076543, s19
    s_cmp_eq_u32 s66, 4
    s_cselect_b32 s19, 0x32107654, s19
    s_cmp_eq_u32 s66, 5
    s_cselect_b32 s19, 0x43210765, s19
    s_cmp_eq_u32 s66, 6
    s_cselect_b32 s19, 0x54321076, s19
    s_cmp_eq_u32 s66, 7
    s_cselect_b32 s19, 0x65432107, s19
    s_mul_i32 s62, s66, 5
    s_mul_i32 s55, s65, 4
    s_add_u32 s62, s62, s55
    s_mul_i32 s55, s53, 8
    s_add_u32 s62, s62, s55
    s_add_u32 s55, s65, 1
    v_add_u32 v16, 0, v0
    v_mul_u32_u24 v17, 6554, v16
    v_lshrrev_b32 v17, 16, v17
    v_mul_u32_u24 v18, 10, v17
    v_sub_u32 v16, v16, v18
    v_lshrrev_b32 v18, 1, v16
    v_add_u32 v19, s55, v18
    v_and_b32 v19, 3, v19
    v_cmp_gt_u32 vcc, 4, v18
    v_and_b32 v16, 1, v16
    v_mul_u32_u24 v17, 1280, v17
    v_cndmask_b32 v18, v18, v19, vcc
    v_lshl_add_u32 v17, v16, 4, v17
    v_lshl_add_u32 v17, v18, 5, v17
    v_subrev_u32 v36, 0, v17
    v_add_u32 v16, 64, v0
    v_mul_u32_u24 v17, 6554, v16
    v_lshrrev_b32 v17, 16, v17
    v_mul_u32_u24 v18, 10, v17
    v_sub_u32 v16, v16, v18
    v_lshrrev_b32 v18, 1, v16
    v_add_u32 v19, s55, v18
    v_and_b32 v19, 3, v19
    v_cmp_gt_u32 vcc, 4, v18
    v_and_b32 v16, 1, v16
    v_mul_u32_u24 v17, 1280, v17
    v_cndmask_b32 v18, v18, v19, vcc
    v_lshl_add_u32 v17, v16, 4, v17
    v_lshl_add_u32 v17, v18, 5, v17
    v_subrev_u32 v37, 1024, v17
    v_add_u32 v16, 128, v0
    v_mul_u32_u24 v17, 6554, v16
    v_lshrrev_b32 v17, 16, v17
    v_mul_u32_u24 v18, 10, v17
    v_sub_u32 v16, v16, v18
    v_lshrrev_b32 v18, 1, v16
    v_add_u32 v19, s55, v18
    v_and_b32 v19, 3, v19
    v_cmp_gt_u32 vcc, 4, v18
    v_and_b32 v16, 1, v16
    v_mul_u32_u24 v17, 1280, v17
    v_cndmask_b32 v18, v18, v19, vcc
    v_lshl_add_u32 v17, v16, 4, v17
    v_lshl_add_u32 v17, v18, 5, v17
    v_subrev_u32 v38, 2048, v17
    v_add_u32 v16, 192, v0
    v_mul_u32_u24 v17, 6554, v16
    v_lshrrev_b32 v17, 16, v17
    v_mul_u32_u24 v18, 10, v17
    v_sub_u32 v16, v16, v18
    v_lshrrev_b32 v18, 1, v16
    v_add_u32 v19, s55, v18
    v_and_b32 v19, 3, v19
    v_cmp_gt_u32 vcc, 4, v18
    v_and_b32 v16, 1, v16
    v_mul_u32_u24 v17, 1280, v17
    v_cndmask_b32 v18, v18, v19, vcc
    v_lshl_add_u32 v17, v16, 4, v17
    v_lshl_add_u32 v17, v18, 5, v17
    v_subrev_u32 v39, 3072, v17
    v_add_u32 v16, 256, v0
    v_mul_u32_u24 v17, 6554, v16
    v_lshrrev_b32 v17, 16, v17
    v_mul_u32_u24 v18, 10, v17
    v_sub_u32 v16, v16, v18
    v_lshrrev_b32 v18, 1, v16
    v_add_u32 v19, s55, v18
    v_and_b32 v19, 3, v19
    v_cmp_gt_u32 vcc, 4, v18
    v_and_b32 v16, 1, v16
    v_mul_u32_u24 v17, 1280, v17
    v_cndmask_b32 v18, v18, v19, vcc
    v_lshl_add_u32 v17, v16, 4, v17
    v_lshl_add_u32 v17, v18, 5, v17
    v_subrev_u32 v40, 0, v17
    v_mov_b32 v54, 0
    v_and_b32 v55, 7, v0
    v_lshlrev_b32 v55, 7, v55
    v_lshlrev_b32 v16, 4, v0
    v_add_u32 v16, 162816, v16
    v_mov_b64 v[48:49], 0
    v_mov_b64 v[50:51], 0
    ds_write_b128 v16, v[48:51]
    v_lshlrev_b32 v4, 2, v0
    v_add_u32 v4, 162816, v4
    v_mov_b32 v5, 0
    v_min_u32 v6, 2, v0
    v_lshlrev_b32 v6, 8, v6
    v_add_u32 v6, 163072, v6
    s_waitcnt lgkmcnt(0)
    s_call_b64 s[58:59], L_qstep
    s_waitcnt vmcnt(34)
    s_barrier
    s_call_b64 s[58:59], L_qstep
    s_waitcnt vmcnt(34)
    s_barrier
    s_call_b64 s[58:59], L_qstep
    s_waitcnt vmcnt(34)
    s_barrier
    s_call_b64 s[58:59], L_qstep
    s_waitcnt vmcnt(34)
    s_barrier
    s_call_b64 s[58:59], L_qstep
    s_waitcnt vmcnt(34)
    s_barrier
    s_call_b64 s[58:59], L_qstep
    s_waitcnt vmcnt(34)
    s_barrier
    s_call_b64 s[58:59], L_qstep
    s_waitcnt vmcnt(34)
    s_barrier
    s_call_b64 s[58:59], L_qstep
    s_waitcnt vmcnt(34)
    s_barrier
    s_call_b64 s[58:59], L_qstep
    s_add_u32 s57, s62, 0
    s_and_b32 s57, s57, 31
    s_lshl_b32 s57, s57, 8
    s_mov_b32 m0, 0
    s_add_u32 s55, s57, 0
    buffer_load_dwordx4 v28, s[20:23], s55 offen offset:0 nt lds
    buffer_load_dwordx4 v29, s[20:23], s55 offen offset:1024 nt lds
    buffer_load_dwordx4 v30, s[20:23], s55 offen offset:2048 nt lds
    buffer_load_dwordx4 v31, s[20:23], s55 offen offset:3072 nt lds
    s_mov_b32 m0, 4096
    s_add_u32 s55, s57, 131072
    buffer_load_dwordx4 v28, s[20:23], s55 offen offset:0 nt lds
    buffer_load_dwordx4 v29, s[20:23], s55 offen offset:1024 nt lds
    buffer_load_dwordx4 v30, s[20:23], s55 offen offset:2048 nt lds
    buffer_load_dwordx4 v31, s[20:23], s55 offen offset:3072 nt lds
    s_add_u32 s57, s62, 1
    s_and_b32 s57, s57, 31
    s_lshl_b32 s57, s57, 8
    s_mov_b32 m0, 16384
    s_add_u32 s55, s57, 0
    buffer_load_dwordx4 v28, s[20:23], s55 offen offset:0 nt lds
    buffer_load_dwordx4 v29, s[20:23], s55 offen offset:1024 nt lds
    buffer_load_dwordx4 v30, s[20:23], s55 offen offset:2048 nt lds
    buffer_load_dwordx4 v31, s[20:23], s55 offen offset:3072 nt lds
    s_mov_b32 m0, 20480
    s_add_u32 s55, s57, 131072
    buffer_load_dwordx4 v28, s[20:23], s55 offen offset:0 nt lds
    buffer_load_dwordx4 v29, s[20:23], s55 offen offset:1024 nt lds
    buffer_load_dwordx4 v30, s[20:23], s55 offen offset:2048 nt lds
    buffer_load_dwordx4 v31, s[20:23], s55 offen offset:3072 nt lds
    s_add_u32 s57, s62, 0
    s_and_b32 s57, s57, 31
    s_lshl_b32 s57, s57, 8
    s_mov_b32 m0, 8192
    s_add_u32 s55, s57, 0
    buffer_load_dwordx4 v32, s[24:27], s55 offen offset:0 nt lds
    buffer_load_dwordx4 v33, s[24:27], s55 offen offset:1024 nt lds
    buffer_load_dwordx4 v34, s[24:27], s55 offen offset:2048 nt lds
    buffer_load_dwordx4 v35, s[24:27], s55 offen offset:3072 nt lds
    s_mov_b32 m0, 12288
    s_add_u32 s55, s57, 131072
    buffer_load_dwordx4 v32, s[24:27], s55 offen offset:0 nt lds
    buffer_load_dwordx4 v33, s[24:27], s55 offen offset:1024 nt lds
    buffer_load_dwordx4 v34, s[24:27], s55 offen offset:2048 nt lds
    buffer_load_dwordx4 v35, s[24:27], s55 offen offset:3072 nt lds
    s_waitcnt vmcnt(58)
    s_barrier
    s_add_u32 s57, s62, 2
    s_and_b32 s57, s57, 31
    s_lshl_b32 s57, s57, 8
    s_mov_b32 m0, 32768
    s_add_u32 s55, s57, 0
    buffer_load_dwordx4 v28, s[20:23], s55 offen offset:0 nt lds
    buffer_load_dwordx4 v29, s[20:23], s55 offen offset:1024 nt lds
    buffer_load_dwordx4 v30, s[20:23], s55 offen offset:2048 nt lds
    buffer_load_dwordx4 v31, s[20:23], s55 offen offset:3072 nt lds
    s_mov_b32 m0, 36864
    s_add_u32 s55, s57, 131072
    buffer_load_dwordx4 v28, s[20:23], s55 offen offset:0 nt lds
    buffer_load_dwordx4 v29, s[20:23], s55 offen offset:1024 nt lds
    buffer_load_dwordx4 v30, s[20:23], s55 offen offset:2048 nt lds
    buffer_load_dwordx4 v31, s[20:23], s55 offen offset:3072 nt lds
    s_add_u32 s57, s62, 1
    s_and_b32 s57, s57, 31
    s_lshl_b32 s57, s57, 8
    s_mov_b32 m0, 24576
    s_add_u32 s55, s57, 0
    buffer_load_dwordx4 v32, s[24:27], s55 offen offset:0 nt lds
    buffer_load_dwordx4 v33, s[24:27], s55 offen offset:1024 nt lds
    buffer_load_dwordx4 v34, s[24:27], s55 offen offset:2048 nt lds
    buffer_load_dwordx4 v35, s[24:27], s55 offen offset:3072 nt lds
    s_mov_b32 m0, 28672
    s_add_u32 s55, s57, 131072
    buffer_load_dwordx4 v32, s[24:27], s55 offen offset:0 nt lds
    buffer_load_dwordx4 v33, s[24:27], s55 offen offset:1024 nt lds
    buffer_load_dwordx4 v34, s[24:27], s55 offen offset:2048 nt lds
    buffer_load_dwordx4 v35, s[24:27], s55 offen offset:3072 nt lds
    s_waitcnt vmcnt(40)
    s_barrier
    s_add_u32 s57, s62, 3
    s_and_b32 s57, s57, 31
    s_lshl_b32 s57, s57, 8
    s_mov_b32 m0, 49152
    s_add_u32 s55, s57, 0
    buffer_load_dwordx4 v28, s[20:23], s55 offen offset:0 nt lds
    buffer_load_dwordx4 v29, s[20:23], s55 offen offset:1024 nt lds
    buffer_load_dwordx4 v30, s[20:23], s55 offen offset:2048 nt lds
    buffer_load_dwordx4 v31, s[20:23], s55 offen offset:3072 nt lds
    s_mov_b32 m0, 53248
    s_add_u32 s55, s57, 131072
    buffer_load_dwordx4 v28, s[20:23], s55 offen offset:0 nt lds
    buffer_load_dwordx4 v29, s[20:23], s55 offen offset:1024 nt lds
    buffer_load_dwordx4 v30, s[20:23], s55 offen offset:2048 nt lds
    buffer_load_dwordx4 v31, s[20:23], s55 offen offset:3072 nt lds
    s_add_u32 s57, s62, 2
    s_and_b32 s57, s57, 31
    s_lshl_b32 s57, s57, 8
    s_mov_b32 m0, 40960
    s_add_u32 s55, s57, 0
    buffer_load_dwordx4 v32, s[24:27], s55 offen offset:0 nt lds
    buffer_load_dwordx4 v33, s[24:27], s55 offen offset:1024 nt lds
    buffer_load_dwordx4 v34, s[24:27], s55 offen offset:2048 nt lds
    buffer_load_dwordx4 v35, s[24:27], s55 offen offset:3072 nt lds
    s_mov_b32 m0, 45056
    s_add_u32 s55, s57, 131072
    buffer_load_dwordx4 v32, s[24:27], s55 offen offset:0 nt lds
    buffer_load_dwordx4 v33, s[24:27], s55 offen offset:1024 nt lds
    buffer_load_dwordx4 v34, s[24:27], s55 offen offset:2048 nt lds
    buffer_load_dwordx4 v35, s[24:27], s55 offen offset:3072 nt lds
    s_waitcnt vmcnt(48)
    s_barrier
    s_mul_i32 s76, s65, 1310720
    s_mul_i32 s55, s66, 160
    s_add_u32 s76, s76, s55
    v_lshrrev_b32 v18, 1, v0
    v_mul_u32_u24 v18, 1280, v18
    v_and_b32 v19, 1, v0
    v_mul_u32_u24 v19, 156, v19
    v_add_u32 v46, v18, v19
    s_mov_b32 s68, 3
    s_mov_b32 s69, 0
    s_mov_b32 s70, 0
L_kv:
    s_cmp_ge_u32 s68, 19
    s_cselect_b32 s55, 2, 6
    s_max_u32 s75, s68, 6
    s_sub_u32 s75, s75, s55
    s_cmp_ge_u32 s69, s75
    s_cbranch_scc1 L_have0
    s_call_b64 s[58:59], L_need
L_have0:
    s_add_u32 s73, s68, 1
    s_cmp_ge_u32 s73, 16
    s_cselect_b32 s56, 3, 7
    s_and_b32 s56, s73, s56
    s_lshl_b32 s56, s56, 14
    s_add_u32 s57, s62, s73
    s_and_b32 s57, s57, 31
    s_lshl_b32 s57, s57, 8
    s_add_u32 m0, s56, 0
    s_add_u32 s55, s57, 0
    buffer_load_dwordx4 v28, s[20:23], s55 offen offset:0 nt lds
    buffer_load_dwordx4 v29, s[20:23], s55 offen offset:1024 nt lds
    buffer_load_dwordx4 v30, s[20:23], s55 offen offset:2048 nt lds
    buffer_load_dwordx4 v31, s[20:23], s55 offen offset:3072 nt lds
    s_add_u32 m0, s56, 4096
    s_add_u32 s55, s57, 131072
    buffer_load_dwordx4 v28, s[20:23], s55 offen offset:0 nt lds
    buffer_load_dwordx4 v29, s[20:23], s55 offen offset:1024 nt lds
    buffer_load_dwordx4 v30, s[20:23], s55 offen offset:2048 nt lds
    buffer_load_dwordx4 v31, s[20:23], s55 offen offset:3072 nt lds
    s_cmp_ge_u32 s68, 16
    s_cselect_b32 s56, 3, 7
    s_and_b32 s56, s68, s56
    s_lshl_b32 s56, s56, 14
    s_add_u32 s56, s56, 8192
    s_add_u32 s57, s62, s68
    s_and_b32 s57, s57, 31
    s_lshl_b32 s57, s57, 8
    s_add_u32 m0, s56, 0
    s_add_u32 s55, s57, 0
    buffer_load_dwordx4 v32, s[24:27], s55 offen offset:0 nt lds
    buffer_load_dwordx4 v33, s[24:27], s55 offen offset:1024 nt lds
    buffer_load_dwordx4 v34, s[24:27], s55 offen offset:2048 nt lds
    buffer_load_dwordx4 v35, s[24:27], s55 offen offset:3072 nt lds
    s_add_u32 m0, s56, 4096
    s_add_u32 s55, s57, 131072
    buffer_load_dwordx4 v32, s[24:27], s55 offen offset:0 nt lds
    buffer_load_dwordx4 v33, s[24:27], s55 offen offset:1024 nt lds
    buffer_load_dwordx4 v34, s[24:27], s55 offen offset:2048 nt lds
    buffer_load_dwordx4 v35, s[24:27], s55 offen offset:3072 nt lds
    s_sub_u32 s72, s68, 7
    s_mov_b32 s56, 13
    s_cmp_lt_u32 s72, 6
    s_cbranch_scc1 L_kv_w
    s_sub_u32 s72, s68, 19
    s_cmp_ge_u32 s72, 12
    s_cbranch_scc1 L_kv_now
    s_add_u32 s72, s72, 6
    s_mov_b32 s56, -6
L_kv_w:
    s_add_u32 s56, s56, s72
    s_mul_i32 s61, s56, 5120
    s_add_u32 s61, s61, 65536
    s_and_b32 s56, s72, 28
    s_lshr_b32 s56, s19, s56
    s_and_b32 s56, s56, 7
    s_and_b32 s55, s72, 3
    s_lshl2_add_u32 s56, s56, s55
    s_mul_i32 s74, s56, 40960
    s_add_u32 s74, s74, s76
    s_mov_b32 m0, s61
    s_mov_b32 s55, s74
    buffer_load_dwordx4 v36, s[36:39], s55 offen offset:0  lds
    buffer_load_dwordx4 v37, s[36:39], s55 offen offset:1024  lds
    buffer_load_dwordx4 v38, s[36:39], s55 offen offset:2048  lds
    buffer_load_dwordx4 v39, s[36:39], s55 offen offset:3072  lds
    s_add_u32 m0, s61, 4096
    s_add_u32 s74, s74, 40960
    buffer_load_dwordx4 v40, s[36:39], s55 offen  lds
    s_branch L_kv_pub
L_kv_now:
    s_sub_u32 s72, s68, 13
    s_cmp_ge_u32 s72, 2
    s_cbranch_scc1 L_kv_pub
    s_and_b32 s55, s53, 7
    s_mul_i32 s72, s72, 8
    s_add_u32 s72, s72, s55
    s_add_u32 s72, s72, 18
    s_cmp_ge_u32 s72, 32
    s_cbranch_scc1 L_kv_pub
    s_and_b32 s56, s72, 28
    s_lshr_b32 s56, s19, s56
    s_and_b32 s56, s56, 7
    s_and_b32 s55, s72, 3
    s_lshl2_add_u32 s56, s56, s55
    s_mul_i32 s74, s56, 40960
    s_add_u32 s74, s74, s76
    buffer_load_dword v19, v46, s[36:39], s74 offen
L_kv_pub:
    s_sub_u32 s56, s68, 1
    s_max_u32 s70, s70, s56
    s_waitcnt vmcnt(32)
    v_writelane_b32 v5, s70, 0
    ds_write_b32 v4, v5
    s_and_b32 s55, s68, 3
    s_cmp_eq_u32 s55, 3
    s_cbranch_scc1 L_kv_x
L_kv_n:
    s_add_u32 s68, s68, 1
    s_cmp_lt_u32 s68, 31
    s_cbranch_scc1 L_kv
    s_mov_b32 s75, 29
    s_cmp_ge_u32 s69, s75
    s_cbranch_scc1 L_have1
    s_call_b64 s[58:59], L_need
L_have1:
    s_add_u32 s57, s62, 31
    s_and_b32 s57, s57, 31
    s_lshl_b32 s57, s57, 8
    s_mov_b32 m0, 57344
    s_add_u32 s55, s57, 0
    buffer_load_dwordx4 v32, s[24:27], s55 offen offset:0 nt lds
    buffer_load_dwordx4 v33, s[24:27], s55 offen offset:1024 nt lds
    buffer_load_dwordx4 v34, s[24:27], s55 offen offset:2048 nt lds
    buffer_load_dwordx4 v35, s[24:27], s55 offen offset:3072 nt lds
    s_mov_b32 m0, 61440
    s_add_u32 s55, s57, 131072
    buffer_load_dwordx4 v32, s[24:27], s55 offen offset:0 nt lds
    buffer_load_dwordx4 v33, s[24:27], s55 offen offset:1024 nt lds
    buffer_load_dwordx4 v34, s[24:27], s55 offen offset:2048 nt lds
    buffer_load_dwordx4 v35, s[24:27], s55 offen offset:3072 nt lds
    s_waitcnt vmcnt(24)
    s_max_u32 s70, s70, 30
    v_writelane_b32 v5, s70, 0
    ds_write_b32 v4, v5
    s_bfe_u32 s56, s19, 0x30010
    s_mul_i32 s74, s56, 163840
    s_add_u32 s74, s74, s76
    s_add_u32 s74, s74, 81920
    s_mov_b32 m0, 126976
    s_mov_b32 s55, s74
    buffer_load_dwordx4 v36, s[36:39], s55 offen offset:0  lds
    buffer_load_dwordx4 v37, s[36:39], s55 offen offset:1024  lds
    buffer_load_dwordx4 v38, s[36:39], s55 offen offset:2048  lds
    buffer_load_dwordx4 v39, s[36:39], s55 offen offset:3072  lds
    s_mov_b32 m0, 131072
    s_add_u32 s74, s74, 40960
    buffer_load_dwordx4 v40, s[36:39], s55 offen  lds
    s_waitcnt vmcnt(13)
    s_max_u32 s70, s70, 31
    v_writelane_b32 v5, s70, 0
    ds_write_b32 v4, v5
    s_waitcnt vmcnt(5)
    s_max_u32 s70, s70, 32
    v_writelane_b32 v5, s70, 0
    ds_write_b32 v4, v5
    s_waitcnt vmcnt(0)
    s_max_u32 s70, s70, 33
    v_writelane_b32 v5, s70, 0
    ds_write_b32 v4, v5
    s_mov_b32 s75, 30
    s_cmp_ge_u32 s69, s75
    s_cbranch_scc1 L_have2
    s_call_b64 s[58:59], L_need
L_have2:
    s_bfe_u32 s56, s19, 0x30010
    s_mul_i32 s74, s56, 163840
    s_add_u32 s74, s74, s76
    s_add_u32 s74, s74, 122880
    s_mov_b32 m0, 0
    s_mov_b32 s55, s74
    buffer_load_dwordx4 v36, s[36:39], s55 offen offset:0  lds
    buffer_load_dwordx4 v37, s[36:39], s55 offen offset:1024  lds
    buffer_load_dwordx4 v38, s[36:39], s55 offen offset:2048  lds
    buffer_load_dwordx4 v39, s[36:39], s55 offen offset:3072  lds
    s_mov_b32 m0, 4096
    s_add_u32 s74, s74, 40960
    buffer_load_dwordx4 v40, s[36:39], s55 offen  lds
    s_bfe_u32 s56, s19, 0x30014
    s_mul_i32 s74, s56, 163840
    s_add_u32 s74, s74, s76
    s_mov_b32 m0, 5120
    s_mov_b32 s55, s74
    buffer_load_dwordx4 v36, s[36:39], s55 offen offset:0  lds
    buffer_load_dwordx4 v37, s[36:39], s55 offen offset:1024  lds
    buffer_load_dwordx4 v38, s[36:39], s55 offen offset:2048  lds
    buffer_load_dwordx4 v39, s[36:39], s55 offen offset:3072  lds
    s_mov_b32 m0, 9216
    s_add_u32 s74, s74, 40960
    buffer_load_dwordx4 v40, s[36:39], s55 offen  lds
    s_mov_b32 m0, 10240
    s_mov_b32 s55, s74
    buffer_load_dwordx4 v36, s[36:39], s55 offen offset:0  lds
    buffer_load_dwordx4 v37, s[36:39], s55 offen offset:1024  lds
    buffer_load_dwordx4 v38, s[36:39], s55 offen offset:2048  lds
    buffer_load_dwordx4 v39, s[36:39], s55 offen offset:3072  lds
    s_mov_b32 m0, 14336
    s_add_u32 s74, s74, 40960
    buffer_load_dwordx4 v40, s[36:39], s55 offen  lds
    s_mov_b32 s75, 31
    s_cmp_ge_u32 s69, s75
    s_cbranch_scc1 L_have3
    s_call_b64 s[58:59], L_need
L_have3:
    s_mov_b32 m0, 15360
    s_mov_b32 s55, s74
    buffer_load_dwordx4 v36, s[36:39], s55 offen offset:0  lds
    buffer_load_dwordx4 v37, s[36:39], s55 offen offset:1024  lds
    buffer_load_dwordx4 v38, s[36:39], s55 offen offset:2048  lds
    buffer_load_dwordx4 v39, s[36:39], s55 offen offset:3072  lds
    s_mov_b32 m0, 19456
    s_add_u32 s74, s74, 40960
    buffer_load_dwordx4 v40, s[36:39], s55 offen  lds
    s_waitcnt vmcnt(15)
    s_max_u32 s70, s70, 34
    v_writelane_b32 v5, s70, 0
    ds_write_b32 v4, v5
    s_mov_b32 m0, 20480
    s_mov_b32 s55, s74
    buffer_load_dwordx4 v36, s[36:39], s55 offen offset:0  lds
    buffer_load_dwordx4 v37, s[36:39], s55 offen offset:1024  lds
    buffer_load_dwordx4 v38, s[36:39], s55 offen offset:2048  lds
    buffer_load_dwordx4 v39, s[36:39], s55 offen offset:3072  lds
    s_mov_b32 m0, 24576
    s_add_u32 s74, s74, 40960
    buffer_load_dwordx4 v40, s[36:39], s55 offen  lds
    s_waitcnt vmcnt(15)
    s_max_u32 s70, s70, 35
    v_writelane_b32 v5, s70, 0
    ds_write_b32 v4, v5
    s_bfe_u32 s56, s19, 0x30018
    s_mul_i32 s74, s56, 163840
    s_add_u32 s74, s74, s76
    s_mov_b32 m0, 25600
    s_mov_b32 s55, s74
    buffer_load_dwordx4 v36, s[36:39], s55 offen offset:0  lds
    buffer_load_dwordx4 v37, s[36:39], s55 offen offset:1024  lds
    buffer_load_dwordx4 v38, s[36:39], s55 offen offset:2048  lds
    buffer_load_dwordx4 v39, s[36:39], s55 offen offset:3072  lds
    s_mov_b32 m0, 29696
    s_add_u32 s74, s74, 40960
    buffer_load_dwordx4 v40, s[36:39], s55 offen  lds
    s_waitcnt vmcnt(15)
    s_max_u32 s70, s70, 36
    v_writelane_b32 v5, s70, 0
    ds_write_b32 v4, v5
    s_mov_b32 s75, 32
    s_cmp_ge_u32 s69, s75
    s_cbranch_scc1 L_have4
    s_call_b64 s[58:59], L_need
L_have4:
    s_mov_b32 m0, 30720
    s_mov_b32 s55, s74
    buffer_load_dwordx4 v36, s[36:39], s55 offen offset:0  lds
    buffer_load_dwordx4 v37, s[36:39], s55 offen offset:1024  lds
    buffer_load_dwordx4 v38, s[36:39], s55 offen offset:2048  lds
    buffer_load_dwordx4 v39, s[36:39], s55 offen offset:3072  lds
    s_mov_b32 m0, 34816
    s_add_u32 s74, s74, 40960
    buffer_load_dwordx4 v40, s[36:39], s55 offen  lds
    s_waitcnt vmcnt(15)
    s_max_u32 s70, s70, 37
    v_writelane_b32 v5, s70, 0
    ds_write_b32 v4, v5
    s_mov_b32 m0, 35840
    s_mov_b32 s55, s74
    buffer_load_dwordx4 v36, s[36:39], s55 offen offset:0  lds
    buffer_load_dwordx4 v37, s[36:39], s55 offen offset:1024  lds
    buffer_load_dwordx4 v38, s[36:39], s55 offen offset:2048  lds
    buffer_load_dwordx4 v39, s[36:39], s55 offen offset:3072  lds
    s_mov_b32 m0, 39936
    s_add_u32 s74, s74, 40960
    buffer_load_dwordx4 v40, s[36:39], s55 offen  lds
    s_waitcnt vmcnt(15)
    s_max_u32 s70, s70, 38
    v_writelane_b32 v5, s70, 0
    ds_write_b32 v4, v5
    s_mov_b32 m0, 40960
    s_mov_b32 s55, s74
    buffer_load_dwordx4 v36, s[36:39], s55 offen offset:0  lds
    buffer_load_dwordx4 v37, s[36:39], s55 offen offset:1024  lds
    buffer_load_dwordx4 v38, s[36:39], s55 offen offset:2048  lds
    buffer_load_dwordx4 v39, s[36:39], s55 offen offset:3072  lds
    s_mov_b32 m0, 45056
    s_add_u32 s74, s74, 40960
    buffer_load_dwordx4 v40, s[36:39], s55 offen  lds
    s_waitcnt vmcnt(15)
    s_max_u32 s70, s70, 39
    v_writelane_b32 v5, s70, 0
    ds_write_b32 v4, v5
    s_mov_b32 s75, 33
    s_cmp_ge_u32 s69, s75
    s_cbranch_scc1 L_have5
    s_call_b64 s[58:59], L_need
L_have5:
    s_bfe_u32 s56, s19, 0x3001c
    s_mul_i32 s74, s56, 163840
    s_add_u32 s74, s74, s76
    s_mov_b32 m0, 46080
    s_mov_b32 s55, s74
    buffer_load_dwordx4 v36, s[36:39], s55 offen offset:0  lds
    buffer_load_dwordx4 v37, s[36:39], s55 offen offset:1024  lds
    buffer_load_dwordx4 v38, s[36:39], s55 offen offset:2048  lds
    buffer_load_dwordx4 v39, s[36:39], s55 offen offset:3072  lds
    s_mov_b32 m0, 50176
    s_add_u32 s74, s74, 40960
    buffer_load_dwordx4 v40, s[36:39], s55 offen  lds
    s_waitcnt vmcnt(15)
    s_max_u32 s70, s70, 40
    v_writelane_b32 v5, s70, 0
    ds_write_b32 v4, v5
    s_mov_b32 m0, 51200
    s_mov_b32 s55, s74
    buffer_load_dwordx4 v36, s[36:39], s55 offen offset:0  lds
    buffer_load_dwordx4 v37, s[36:39], s55 offen offset:1024  lds
    buffer_load_dwordx4 v38, s[36:39], s55 offen offset:2048  lds
    buffer_load_dwordx4 v39, s[36:39], s55 offen offset:3072  lds
    s_mov_b32 m0, 55296
    s_add_u32 s74, s74, 40960
    buffer_load_dwordx4 v40, s[36:39], s55 offen  lds
    s_waitcnt vmcnt(15)
    s_max_u32 s70, s70, 41
    v_writelane_b32 v5, s70, 0
    ds_write_b32 v4, v5
    s_mov_b32 m0, 56320
    s_mov_b32 s55, s74
    buffer_load_dwordx4 v36, s[36:39], s55 offen offset:0  lds
    buffer_load_dwordx4 v37, s[36:39], s55 offen offset:1024  lds
    buffer_load_dwordx4 v38, s[36:39], s55 offen offset:2048  lds
    buffer_load_dwordx4 v39, s[36:39], s55 offen offset:3072  lds
    s_mov_b32 m0, 60416
    s_add_u32 s74, s74, 40960
    buffer_load_dwordx4 v40, s[36:39], s55 offen  lds
    s_waitcnt vmcnt(15)
    s_max_u32 s70, s70, 42
    v_writelane_b32 v5, s70, 0
    ds_write_b32 v4, v5
    s_waitcnt vmcnt(10)
    s_max_u32 s70, s70, 43
    v_writelane_b32 v5, s70, 0
    ds_write_b32 v4, v5
    s_waitcnt vmcnt(5)
    s_max_u32 s70, s70, 44
    v_writelane_b32 v5, s70, 0
    ds_write_b32 v4, v5
    s_waitcnt vmcnt(0)
    s_max_u32 s70, s70, 45
    v_writelane_b32 v5, s70, 0
    ds_write_b32 v4, v5
    s_mov_b32 s75, 34
    s_cmp_ge_u32 s69, s75
    s_cbranch_scc1 L_have6
    s_call_b64 s[58:59], L_need
L_have6:
    s_mov_b32 m0, 132096
    s_mov_b32 s55, s74
    buffer_load_dwordx4 v36, s[36:39], s55 offen offset:0  lds
    buffer_load_dwordx4 v37, s[36:39], s55 offen offset:1024  lds
    buffer_load_dwordx4 v38, s[36:39], s55 offen offset:2048  lds
    buffer_load_dwordx4 v39, s[36:39], s55 offen offset:3072  lds
    s_mov_b32 m0, 136192
    s_add_u32 s74, s74, 40960
    buffer_load_dwordx4 v40, s[36:39], s55 offen  lds
    s_waitcnt vmcnt(0)
    s_max_u32 s70, s70, 46
    v_writelane_b32 v5, s70, 0
    ds_write_b32 v4, v5
    s_endpgm
L_kv_x:
    s_cmp_lg_u32 s68, 3
    s_cbranch_scc1 L_kv_x7
    buffer_load_dwordx2 v[52:53], v54, s[40:43], 0 offen sc1
    s_branch L_kv_n
L_kv_x7:
    s_cmp_lg_u32 s68, 7
    s_cbranch_scc1 L_kv_x27
    s_mov_b32 s67, 0
L_tag:
    v_readfirstlane_b32 s101, v53
    v_readfirstlane_b32 s100, v52
    s_add_u32 s67, s67, 1
    s_cmp_lg_u32 s101, 0
    s_cbranch_scc1 L_tag_ok
    s_cmp_ge_u32 s67, 0x40000
    s_cbranch_scc1 L_tag_ok
    s_sleep 8
    buffer_load_dwordx2 v[52:53], v54, s[40:43], 0 offen sc1
    s_waitcnt vmcnt(0)
    s_branch L_tag
L_tag_ok:
    v_writelane_b32 v5, s100, 1
    v_writelane_b32 v5, s101, 2
    s_branch L_kv_n
L_kv_x27:
    s_cmp_lg_u32 s68, 27
    s_cbranch_scc1 L_kv_n
    s_lshl_b32 s55, s54, 9
    s_add_u32 s55, s55, 16777216
    s_mov_b64 exec, 7
    buffer_load_dword v19, v55, s[44:47], s55 offen
    s_mov_b64 exec, -1
    s_getpc_b64 s[96:97]
L_pc0:
    s_sub_u32 s96, s96, L_pc0-standalone__mha_block_cached__near_ridge_kernel
    s_subb_u32 s97, s97, 0
    s_mov_b32 s98, L_code_end-standalone__mha_block_cached__near_ridge_kernel
    s_mov_b32 s99, 0x20000
    s_and_b32 s55, s64, 3
    s_lshl_b32 s55, s55, 13
    v_lshlrev_b32 v18, 7, v0
    buffer_load_dword v19, v18, s[96:99], s55 offen
    s_branch L_kv_n
L_need:
    s_mov_b32 s67, 0
L_need_spin:
    ds_read_b32 v7, v6
    s_waitcnt lgkmcnt(0)
    v_readlane_b32 s69, v7, 0
    v_readlane_b32 s55, v7, 1
    v_readlane_b32 s56, v7, 2
    s_nop 0
    s_min_u32 s69, s69, s55
    s_min_u32 s69, s69, s56
    s_cmp_ge_u32 s69, s75
    s_cbranch_scc1 L_need_ret
    s_add_u32 s67, s67, 1
    s_cmp_lt_u32 s67, 1048576
    s_cbranch_scc1 L_need_spin
L_need_ret:
    s_setpc_b64 s[58:59]
L_compute:
    s_getpc_b64 s[96:97]
L_pc1:
    s_sub_u32 s96, s96, L_pc1-standalone__mha_block_cached__near_ridge_kernel
    s_subb_u32 s97, s97, 0
    s_mov_b32 s98, L_code_end-standalone__mha_block_cached__near_ridge_kernel
    s_mov_b32 s99, 0x20000
    s_and_b32 s55, s64, 3
    s_lshl_b32 s55, s55, 13
    v_lshlrev_b32 v1, 7, v0
    s_cmp_lg_u32 s3, 0
    s_cbranch_scc1 L_nopf
    buffer_load_dword v251, v1, s[96:99], s55 offen
L_nopf:
    s_waitcnt lgkmcnt(0)
    s_mov_b32 s48, s14
    s_mov_b32 s49, s15
    s_mov_b32 s50, 1474560
    s_mov_b32 s51, 0x20000
    s_mov_b32 s40, s16
    s_mov_b32 s41, s17
    s_mov_b32 s42, 256
    s_mov_b32 s43, 0x20000
    s_mov_b32 s44, s18
    s_mov_b32 s45, s19
    s_mov_b32 s46, 268435456
    s_mov_b32 s47, 0x20000
    s_mov_b32 s19, 0x76543210
    s_cmp_eq_u32 s66, 1
    s_cselect_b32 s19, 0x7654321, s19
    s_cmp_eq_u32 s66, 2
    s_cselect_b32 s19, 0x10765432, s19
    s_cmp_eq_u32 s66, 3
    s_cselect_b32 s19, 0x21076543, s19
    s_cmp_eq_u32 s66, 4
    s_cselect_b32 s19, 0x32107654, s19
    s_cmp_eq_u32 s66, 5
    s_cselect_b32 s19, 0x43210765, s19
    s_cmp_eq_u32 s66, 6
    s_cselect_b32 s19, 0x54321076, s19
    s_cmp_eq_u32 s66, 7
    s_cselect_b32 s19, 0x65432107, s19
    s_lshl_b32 s54, s53, 5
    s_add_u32 s54, s54, s52
    s_lshl2_add_u32 s55, s2, s3
    s_cmp_lg_u32 s55, 1
    s_cbranch_scc1 L_notag
    s_memrealtime s[58:59]
    v_mov_b32 v16, 0
    s_waitcnt lgkmcnt(0)
    s_or_b32 s59, s59, 0x40000000
    v_mov_b32 v18, s58
    v_mov_b32 v19, s59
    s_mov_b64 exec, 1
    buffer_store_dwordx2 v[18:19], v16, s[40:43], 0 offen sc1
    s_mov_b64 exec, -1
    s_nop 1
L_notag:
    v_lshrrev_b32 v1, 4, v0
    v_and_b32 v2, 15, v0
    v_lshrrev_b32 v3, 2, v2
    v_and_b32 v16, 3, v0
    v_and_b32 v17, 1, v1
    v_lshlrev_b32 v18, 1, v17
    v_lshl_or_b32 v17, v17, 2, v3
    v_lshrrev_b32 v19, 1, v1
    v_or_b32 v18, v18, v19
    v_lshl_add_u32 v19, v1, 3, v3
    v_lshlrev_b32 v19, 8, v19
    v_lshl_add_u32 v19, v16, 3, v19
    v_add_u32 v19, 58368, v19
    v_xor_b32 v20, 0, v17
    v_lshl_add_u32 v240, v20, 5, v19
    v_xor_b32 v20, 1, v17
    v_lshl_add_u32 v241, v20, 5, v19
    v_xor_b32 v20, 2, v17
    v_lshl_add_u32 v242, v20, 5, v19
    v_xor_b32 v20, 3, v17
    v_lshl_add_u32 v243, v20, 5, v19
    v_xor_b32 v20, 4, v17
    v_lshl_add_u32 v244, v20, 5, v19
    v_xor_b32 v20, 5, v17
    v_lshl_add_u32 v245, v20, 5, v19
    v_xor_b32 v20, 6, v17
    v_lshl_add_u32 v246, v20, 5, v19
    v_xor_b32 v20, 7, v17
    v_lshl_add_u32 v247, v20, 5, v19
    s_mul_i32 s55, s3, 6144
    s_add_u32 s55, s55, 74752
    v_lshlrev_b32 v19, 7, v2
    v_add_u32 v19, s55, v19
    v_lshrrev_b32 v21, 1, v2
    v_or_b32 v20, 0, v1
    v_xor_b32 v20, v20, v21
    v_lshl_add_u32 v248, v20, 4, v19
    v_or_b32 v20, 4, v1
    v_xor_b32 v20, v20, v21
    v_lshl_add_u32 v249, v20, 4, v19
    v_lshlrev_b32 v19, 8, v2
    v_or_b32 v20, 0, v18
    v_xor_b32 v20, v20, v2
    v_lshl_add_u32 v228, v20, 4, v19
    v_or_b32 v20, 4, v18
    v_xor_b32 v20, v20, v2
    v_lshl_add_u32 v229, v20, 4, v19
    v_or_b32 v20, 8, v18
    v_xor_b32 v20, v20, v2
    v_lshl_add_u32 v230, v20, 4, v19
    v_or_b32 v20, 12, v18
    v_xor_b32 v20, v20, v2
    v_lshl_add_u32 v231, v20, 4, v19
    v_lshl_add_u32 v19, v1, 2, v3
    v_lshlrev_b32 v19, 8, v19
    v_lshl_add_u32 v19, v16, 3, v19
    v_add_u32 v19, 73728, v19
    v_xor_b32 v20, 0, v17
    v_lshl_add_u32 v232, v20, 5, v19
    v_xor_b32 v20, 1, v17
    v_lshl_add_u32 v233, v20, 5, v19
    v_xor_b32 v20, 2, v17
    v_lshl_add_u32 v234, v20, 5, v19
    v_xor_b32 v20, 3, v17
    v_lshl_add_u32 v235, v20, 5, v19
    v_xor_b32 v20, 4, v17
    v_lshl_add_u32 v236, v20, 5, v19
    v_xor_b32 v20, 5, v17
    v_lshl_add_u32 v237, v20, 5, v19
    v_xor_b32 v20, 6, v17
    v_lshl_add_u32 v238, v20, 5, v19
    v_xor_b32 v20, 7, v17
    v_lshl_add_u32 v239, v20, 5, v19
    v_mov_b32 v4, 162816
    v_mov_b32 v7, 0
    s_lshl_b32 s55, s3, 8
    s_add_u32 s55, s55, 163072
    v_lshlrev_b32 v19, 2, v0
    v_add_u32 v6, s55, v19
    v_lshrrev_b32 v19, 2, v0
    v_mul_u32_u24 v19, 160, v19
    v_lshl_add_u32 v8, v16, 3, v19
    v_add_u32 v9, 65536, v8
    v_add_u32 v10, 126976, v8
    v_mov_b64 v[16:17], 0
    v_mov_b64 v[18:19], 0
    v_mov_b64 v[20:21], 0
    v_mov_b64 v[22:23], 0
    v_mov_b64 v[24:25], 0
    v_mov_b64 v[26:27], 0
    v_mov_b64 v[28:29], 0
    v_mov_b64 v[30:31], 0
    v_mov_b64 v[32:33], 0
    v_mov_b64 v[34:35], 0
    v_mov_b64 v[36:37], 0
    v_mov_b64 v[38:39], 0
    v_mov_b64 v[40:41], 0
    v_mov_b64 v[42:43], 0
    v_mov_b64 v[44:45], 0
    v_mov_b64 v[46:47], 0
    v_mov_b64 v[48:49], 0
    v_mov_b64 v[50:51], 0
    v_mov_b64 v[52:53], 0
    v_mov_b64 v[54:55], 0
    v_mov_b64 v[56:57], 0
    v_mov_b64 v[58:59], 0
    v_mov_b64 v[60:61], 0
    v_mov_b64 v[62:63], 0
    v_mov_b64 v[64:65], 0
    v_mov_b64 v[66:67], 0
    v_mov_b64 v[68:69], 0
    v_mov_b64 v[70:71], 0
    v_mov_b64 v[72:73], 0
    v_mov_b64 v[74:75], 0
    v_mov_b64 v[76:77], 0
    v_mov_b64 v[78:79], 0
    v_mov_b64 v[80:81], 0
    v_mov_b64 v[82:83], 0
    v_mov_b64 v[84:85], 0
    v_mov_b64 v[86:87], 0
    v_mov_b64 v[88:89], 0
    v_mov_b64 v[90:91], 0
    v_mov_b64 v[92:93], 0
    v_mov_b64 v[94:95], 0
    v_mov_b64 v[96:97], 0
    v_mov_b64 v[98:99], 0
    v_mov_b64 v[100:101], 0
    v_mov_b64 v[102:103], 0
    v_mov_b64 v[104:105], 0
    v_mov_b64 v[106:107], 0
    v_mov_b64 v[108:109], 0
    v_mov_b64 v[110:111], 0
    v_mov_b64 v[112:113], 0
    v_mov_b64 v[114:115], 0
    v_mov_b64 v[116:117], 0
    v_mov_b64 v[118:119], 0
    v_mov_b64 v[120:121], 0
    v_mov_b64 v[122:123], 0
    v_mov_b64 v[176:177], 0
    v_mov_b64 v[178:179], 0
    v_mov_b32 v252, 0x3f803f80
    v_mov_b32 v253, 0x3f803f80
    v_mov_b32 v254, 0x3f803f80
    v_mov_b32 v255, 0x3f803f80
    s_mov_b32 s70, 0xffffffff
    s_mov_b32 s71, 0x1111110
    s_mov_b32 s62, 1
    s_mov_b32 s63, 0x40004000
    s_mov_b32 s68, 0x10000
    s_mov_b32 s61, 0
    s_mov_b32 s56, 34816
    s_mov_b32 s60, 10
    s_barrier
    ds_read_b64_tr_b16 a[0:1], v240 offset:0
    ds_read_b64_tr_b16 a[2:3], v240 offset:1024
    ds_read_b128 a[32:35], v248 offset:0
    ds_read_b64_tr_b16 a[4:5], v241 offset:0
    ds_read_b128 a[36:39], v248 offset:2048
    ds_read_b64_tr_b16 a[6:7], v241 offset:1024
    ds_read_b128 a[40:43], v248 offset:4096
    ds_read_b64_tr_b16 a[8:9], v242 offset:0
    ds_read_b64_tr_b16 a[10:11], v242 offset:1024
    ds_read_b64_tr_b16 a[12:13], v243 offset:0
    ds_read_b64_tr_b16 a[14:15], v243 offset:1024
    ds_read_b64_tr_b16 a[16:17], v244 offset:0
    ds_read_b64_tr_b16 a[18:19], v244 offset:1024
    ds_read_b64_tr_b16 a[20:21], v245 offset:0
    ds_read_b64_tr_b16 a[22:23], v245 offset:1024
    ds_read_b64_tr_b16 a[24:25], v246 offset:0
    ds_read_b64_tr_b16 a[26:27], v246 offset:1024
    ds_read_b64_tr_b16 a[28:29], v247 offset:0
    ds_read_b64_tr_b16 a[30:31], v247 offset:1024
    s_waitcnt lgkmcnt(12)
    .p2align 3
L_q:
    v_mfma_f32_16x16x32_bf16 v[16:19], a[0:3], a[32:35], v[16:19]
    v_mfma_f32_16x16x32_bf16 v[48:51], a[0:3], a[36:39], v[48:51]
    v_mfma_f32_16x16x32_bf16 v[80:83], a[0:3], a[40:43], v[80:83]
    ds_read_b64_tr_b16 a[0:1], v240 offset:8192
    v_mfma_f32_16x16x32_bf16 v[20:23], a[4:7], a[32:35], v[20:23]
    ds_read_b64_tr_b16 a[2:3], v240 offset:9216
    v_mfma_f32_16x16x32_bf16 v[52:55], a[4:7], a[36:39], v[52:55]
    ds_read_b128 a[44:47], v249 offset:0
    v_mfma_f32_16x16x32_bf16 v[84:87], a[4:7], a[40:43], v[84:87]
    s_waitcnt lgkmcnt(11)
    ds_read_b64_tr_b16 a[4:5], v241 offset:8192
    v_mfma_f32_16x16x32_bf16 v[24:27], a[8:11], a[32:35], v[24:27]
    ds_read_b64_tr_b16 a[6:7], v241 offset:9216
    v_mfma_f32_16x16x32_bf16 v[56:59], a[8:11], a[36:39], v[56:59]
    ds_read_b128 a[48:51], v249 offset:2048
    v_mfma_f32_16x16x32_bf16 v[88:91], a[8:11], a[40:43], v[88:91]
    ds_read_b64_tr_b16 a[8:9], v242 offset:8192
    v_mfma_f32_16x16x32_bf16 v[28:31], a[12:15], a[32:35], v[28:31]
    ds_read_b64_tr_b16 a[10:11], v242 offset:9216
    v_mfma_f32_16x16x32_bf16 v[60:63], a[12:15], a[36:39], v[60:63]
    ds_read_b128 a[52:55], v249 offset:4096
    v_mfma_f32_16x16x32_bf16 v[92:95], a[12:15], a[40:43], v[92:95]
    s_waitcnt lgkmcnt(13)
    ds_read_b64_tr_b16 a[12:13], v243 offset:8192
    v_mfma_f32_16x16x32_bf16 v[32:35], a[16:19], a[32:35], v[32:35]
    ds_read_b64_tr_b16 a[14:15], v243 offset:9216
    v_mfma_f32_16x16x32_bf16 v[64:67], a[16:19], a[36:39], v[64:67]
    v_mfma_f32_16x16x32_bf16 v[96:99], a[16:19], a[40:43], v[96:99]
    ds_read_b64_tr_b16 a[16:17], v244 offset:8192
    v_mfma_f32_16x16x32_bf16 v[36:39], a[20:23], a[32:35], v[36:39]
    ds_read_b64_tr_b16 a[18:19], v244 offset:9216
    v_mfma_f32_16x16x32_bf16 v[68:71], a[20:23], a[36:39], v[68:71]
    v_mfma_f32_16x16x32_bf16 v[100:103], a[20:23], a[40:43], v[100:103]
    s_waitcnt lgkmcnt(13)
    ds_read_b64_tr_b16 a[20:21], v245 offset:8192
    v_mfma_f32_16x16x32_bf16 v[40:43], a[24:27], a[32:35], v[40:43]
    ds_read_b64_tr_b16 a[22:23], v245 offset:9216
    v_mfma_f32_16x16x32_bf16 v[72:75], a[24:27], a[36:39], v[72:75]
    v_mfma_f32_16x16x32_bf16 v[104:107], a[24:27], a[40:43], v[104:107]
    ds_read_b64_tr_b16 a[24:25], v246 offset:8192
    v_mfma_f32_16x16x32_bf16 v[44:47], a[28:31], a[32:35], v[44:47]
    ds_read_b64_tr_b16 a[26:27], v246 offset:9216
    v_mfma_f32_16x16x32_bf16 v[76:79], a[28:31], a[36:39], v[76:79]
    v_mfma_f32_16x16x32_bf16 v[108:111], a[28:31], a[40:43], v[108:111]
    s_waitcnt lgkmcnt(8)
    ds_read_b64_tr_b16 a[28:29], v247 offset:8192
    v_mfma_f32_16x16x32_bf16 v[16:19], a[0:3], a[44:47], v[16:19]
    ds_read_b64_tr_b16 a[30:31], v247 offset:9216
    v_mfma_f32_16x16x32_bf16 v[48:51], a[0:3], a[48:51], v[48:51]
    s_add_u32 s61, s61, 1
    v_mfma_f32_16x16x32_bf16 v[80:83], a[0:3], a[52:55], v[80:83]
    s_cmp_eq_u32 s61, 3
    v_mfma_f32_16x16x32_bf16 v[20:23], a[4:7], a[44:47], v[20:23]
    s_cselect_b32 s55, 4294897664, s56
    v_mfma_f32_16x16x32_bf16 v[52:55], a[4:7], a[48:51], v[52:55]
    s_cselect_b32 s61, 0, s61
    v_add_u32 v240, s55, v240
    v_add_u32 v241, s55, v241
    v_mfma_f32_16x16x32_bf16 v[84:87], a[4:7], a[52:55], v[84:87]
    s_waitcnt lgkmcnt(0)
    s_barrier
    v_mfma_f32_16x16x32_bf16 v[24:27], a[8:11], a[44:47], v[24:27]
    ds_read_b64_tr_b16 a[0:1], v240 offset:0
    v_add_u32 v248, s55, v248
    v_mfma_f32_16x16x32_bf16 v[56:59], a[8:11], a[48:51], v[56:59]
    ds_read_b64_tr_b16 a[2:3], v240 offset:1024
    v_add_u32 v242, s55, v242
    v_mfma_f32_16x16x32_bf16 v[88:91], a[8:11], a[52:55], v[88:91]
    ds_read_b128 a[32:35], v248 offset:0
    ds_read_b64_tr_b16 a[4:5], v241 offset:0
    v_mfma_f32_16x16x32_bf16 v[28:31], a[12:15], a[44:47], v[28:31]
    ds_read_b128 a[36:39], v248 offset:2048
    ds_read_b64_tr_b16 a[6:7], v241 offset:1024
    v_mfma_f32_16x16x32_bf16 v[60:63], a[12:15], a[48:51], v[60:63]
    ds_read_b128 a[40:43], v248 offset:4096
    v_add_u32 v249, s55, v249
    v_mfma_f32_16x16x32_bf16 v[92:95], a[12:15], a[52:55], v[92:95]
    ds_read_b64_tr_b16 a[8:9], v242 offset:0
    v_add_u32 v243, s55, v243
    v_mfma_f32_16x16x32_bf16 v[32:35], a[16:19], a[44:47], v[32:35]
    ds_read_b64_tr_b16 a[10:11], v242 offset:1024
    v_add_u32 v244, s55, v244
    v_mfma_f32_16x16x32_bf16 v[64:67], a[16:19], a[48:51], v[64:67]
    ds_read_b64_tr_b16 a[12:13], v243 offset:0
    v_add_u32 v245, s55, v245
    v_mfma_f32_16x16x32_bf16 v[96:99], a[16:19], a[52:55], v[96:99]
    ds_read_b64_tr_b16 a[14:15], v243 offset:1024
    v_add_u32 v246, s55, v246
    v_mfma_f32_16x16x32_bf16 v[36:39], a[20:23], a[44:47], v[36:39]
    ds_read_b64_tr_b16 a[16:17], v244 offset:0
    v_add_u32 v247, s55, v247
    v_mfma_f32_16x16x32_bf16 v[68:71], a[20:23], a[48:51], v[68:71]
    ds_read_b64_tr_b16 a[18:19], v244 offset:1024
    v_mfma_f32_16x16x32_bf16 v[100:103], a[20:23], a[52:55], v[100:103]
    ds_read_b64_tr_b16 a[20:21], v245 offset:0
    v_mfma_f32_16x16x32_bf16 v[40:43], a[24:27], a[44:47], v[40:43]
    ds_read_b64_tr_b16 a[22:23], v245 offset:1024
    v_mfma_f32_16x16x32_bf16 v[72:75], a[24:27], a[48:51], v[72:75]
    s_sub_u32 s60, s60, 1
    v_mfma_f32_16x16x32_bf16 v[104:107], a[24:27], a[52:55], v[104:107]
    s_cmp_lg_u32 s60, 0
    ds_read_b64_tr_b16 a[24:25], v246 offset:0
    v_mfma_f32_16x16x32_bf16 v[44:47], a[28:31], a[44:47], v[44:47]
    ds_read_b64_tr_b16 a[26:27], v246 offset:1024
    v_mfma_f32_16x16x32_bf16 v[76:79], a[28:31], a[48:51], v[76:79]
    s_waitcnt lgkmcnt(10)
    v_mfma_f32_16x16x32_bf16 v[108:111], a[28:31], a[52:55], v[108:111]
    ds_read_b64_tr_b16 a[28:29], v247 offset:0
    ds_read_b64_tr_b16 a[30:31], v247 offset:1024
    s_cbranch_scc1 L_q
    s_waitcnt lgkmcnt(0)
    ds_read_b128 a[0:3], v228 offset:0
    ds_read_b128 a[16:19], v228 offset:4096
    ds_read_b128 a[4:7], v229 offset:0
    ds_read_b128 a[20:23], v229 offset:4096
    ds_read_b128 a[8:11], v230 offset:0
    ds_read_b128 a[24:27], v230 offset:4096
    ds_read_b128 a[12:15], v231 offset:0
    ds_read_b128 a[28:31], v231 offset:4096
    s_mov_b32 s58, 0x3e0293ee
    s_mov_b32 s59, 0x3e0293ee
    s_mov_b32 s60, 8
    v_pk_mul_f32 v[16:17], v[16:17], s[58:59]
    v_pk_mul_f32 v[18:19], v[18:19], s[58:59]
    v_pk_mul_f32 v[20:21], v[20:21], s[58:59]
    v_pk_mul_f32 v[22:23], v[22:23], s[58:59]
    v_pk_mul_f32 v[24:25], v[24:25], s[58:59]
    v_pk_mul_f32 v[26:27], v[26:27], s[58:59]
    v_pk_mul_f32 v[28:29], v[28:29], s[58:59]
    v_pk_mul_f32 v[30:31], v[30:31], s[58:59]
    v_pk_mul_f32 v[32:33], v[32:33], s[58:59]
    v_pk_mul_f32 v[34:35], v[34:35], s[58:59]
    v_pk_mul_f32 v[36:37], v[36:37], s[58:59]
    v_pk_mul_f32 v[38:39], v[38:39], s[58:59]
    v_pk_mul_f32 v[40:41], v[40:41], s[58:59]
    v_pk_mul_f32 v[42:43], v[42:43], s[58:59]
    v_pk_mul_f32 v[44:45], v[44:45], s[58:59]
    v_pk_mul_f32 v[46:47], v[46:47], s[58:59]
    v_cvt_pk_bf16_f32 v180, v16, v17
    v_cvt_pk_bf16_f32 v181, v18, v19
    v_cvt_pk_bf16_f32 v182, v20, v21
    v_cvt_pk_bf16_f32 v183, v22, v23
    v_cvt_pk_bf16_f32 v184, v24, v25
    v_cvt_pk_bf16_f32 v185, v26, v27
    v_cvt_pk_bf16_f32 v186, v28, v29
    v_cvt_pk_bf16_f32 v187, v30, v31
    v_cvt_pk_bf16_f32 v188, v32, v33
    v_cvt_pk_bf16_f32 v189, v34, v35
    v_cvt_pk_bf16_f32 v190, v36, v37
    v_cvt_pk_bf16_f32 v191, v38, v39
    v_cvt_pk_bf16_f32 v192, v40, v41
    v_cvt_pk_bf16_f32 v193, v42, v43
    v_cvt_pk_bf16_f32 v194, v44, v45
    v_cvt_pk_bf16_f32 v195, v46, v47
    v_mov_b64 v[16:17], 0
    v_mov_b64 v[18:19], 0
    v_mov_b64 v[20:21], 0
    v_mov_b64 v[22:23], 0
    v_mov_b64 v[24:25], 0
    v_mov_b64 v[26:27], 0
    v_mov_b64 v[28:29], 0
    v_mov_b64 v[30:31], 0
    v_mov_b64 v[32:33], 0
    v_mov_b64 v[34:35], 0
    v_mov_b64 v[36:37], 0
    v_mov_b64 v[38:39], 0
    v_mov_b64 v[40:41], 0
    v_mov_b64 v[42:43], 0
    v_mov_b64 v[44:45], 0
    v_mov_b64 v[46:47], 0
    v_permlane16_swap_b32 v180, v182
    v_permlane16_swap_b32 v181, v183
    v_permlane16_swap_b32 v184, v186
    v_permlane16_swap_b32 v185, v187
    v_permlane16_swap_b32 v188, v190
    v_permlane16_swap_b32 v189, v191
    v_permlane16_swap_b32 v192, v194
    v_permlane16_swap_b32 v193, v195
    s_nop 0
    v_pk_mul_f32 v[48:49], v[48:49], s[58:59]
    v_pk_mul_f32 v[50:51], v[50:51], s[58:59]
    v_pk_mul_f32 v[52:53], v[52:53], s[58:59]
    v_pk_mul_f32 v[54:55], v[54:55], s[58:59]
    v_pk_mul_f32 v[56:57], v[56:57], s[58:59]
    v_pk_mul_f32 v[58:59], v[58:59], s[58:59]
    v_pk_mul_f32 v[60:61], v[60:61], s[58:59]
    v_pk_mul_f32 v[62:63], v[62:63], s[58:59]
    v_pk_mul_f32 v[64:65], v[64:65], s[58:59]
    v_pk_mul_f32 v[66:67], v[66:67], s[58:59]
    v_pk_mul_f32 v[68:69], v[68:69], s[58:59]
    v_pk_mul_f32 v[70:71], v[70:71], s[58:59]
    v_pk_mul_f32 v[72:73], v[72:73], s[58:59]
    v_pk_mul_f32 v[74:75], v[74:75], s[58:59]
    v_pk_mul_f32 v[76:77], v[76:77], s[58:59]
    v_pk_mul_f32 v[78:79], v[78:79], s[58:59]
    s_waitcnt lgkmcnt(7)
    v_mfma_f32_16x16x32_bf16 v[136:139], a[0:3], v[180:183], 0
    v_cvt_pk_bf16_f32 v196, v48, v49
    v_cvt_pk_bf16_f32 v197, v50, v51
    s_waitcnt lgkmcnt(6)
    v_mfma_f32_16x16x32_bf16 v[140:143], a[16:19], v[180:183], 0
    v_cvt_pk_bf16_f32 v198, v52, v53
    v_cvt_pk_bf16_f32 v199, v54, v55
    s_waitcnt lgkmcnt(5)
    v_mfma_f32_16x16x32_bf16 v[136:139], a[4:7], v[184:187], v[136:139]
    v_cvt_pk_bf16_f32 v200, v56, v57
    v_cvt_pk_bf16_f32 v201, v58, v59
    s_waitcnt lgkmcnt(4)
    v_mfma_f32_16x16x32_bf16 v[140:143], a[20:23], v[184:187], v[140:143]
    v_cvt_pk_bf16_f32 v202, v60, v61
    v_cvt_pk_bf16_f32 v203, v62, v63
    s_waitcnt lgkmcnt(3)
    v_mfma_f32_16x16x32_bf16 v[136:139], a[8:11], v[188:191], v[136:139]
    v_cvt_pk_bf16_f32 v204, v64, v65
    v_cvt_pk_bf16_f32 v205, v66, v67
    s_waitcnt lgkmcnt(2)
    v_mfma_f32_16x16x32_bf16 v[140:143], a[24:27], v[188:191], v[140:143]
    v_cvt_pk_bf16_f32 v206, v68, v69
    v_cvt_pk_bf16_f32 v207, v70, v71
    s_waitcnt lgkmcnt(1)
    v_mfma_f32_16x16x32_bf16 v[136:139], a[12:15], v[192:195], v[136:139]
    v_cvt_pk_bf16_f32 v208, v72, v73
    v_cvt_pk_bf16_f32 v209, v74, v75
    s_waitcnt lgkmcnt(0)
    v_mfma_f32_16x16x32_bf16 v[140:143], a[28:31], v[192:195], v[140:143]
    v_cvt_pk_bf16_f32 v210, v76, v77
    v_cvt_pk_bf16_f32 v211, v78, v79
    v_mov_b64 v[48:49], 0
    v_mov_b64 v[50:51], 0
    v_mov_b64 v[52:53], 0
    v_mov_b64 v[54:55], 0
    v_mov_b64 v[56:57], 0
    v_mov_b64 v[58:59], 0
    v_mov_b64 v[60:61], 0
    v_mov_b64 v[62:63], 0
    v_mov_b64 v[64:65], 0
    v_mov_b64 v[66:67], 0
    v_mov_b64 v[68:69], 0
    v_mov_b64 v[70:71], 0
    v_mov_b64 v[72:73], 0
    v_mov_b64 v[74:75], 0
    v_mov_b64 v[76:77], 0
    v_mov_b64 v[78:79], 0
    v_permlane16_swap_b32 v196, v198
    v_permlane16_swap_b32 v197, v199
    v_permlane16_swap_b32 v200, v202
    v_permlane16_swap_b32 v201, v203
    v_permlane16_swap_b32 v204, v206
    v_permlane16_swap_b32 v205, v207
    v_permlane16_swap_b32 v208, v210
    v_permlane16_swap_b32 v209, v211
    s_nop 0
    v_pk_mul_f32 v[80:81], v[80:81], s[58:59]
    v_pk_mul_f32 v[82:83], v[82:83], s[58:59]
    v_pk_mul_f32 v[84:85], v[84:85], s[58:59]
    v_pk_mul_f32 v[86:87], v[86:87], s[58:59]
    v_pk_mul_f32 v[88:89], v[88:89], s[58:59]
    v_pk_mul_f32 v[90:91], v[90:91], s[58:59]
    v_pk_mul_f32 v[92:93], v[92:93], s[58:59]
    v_pk_mul_f32 v[94:95], v[94:95], s[58:59]
    v_pk_mul_f32 v[96:97], v[96:97], s[58:59]
    v_pk_mul_f32 v[98:99], v[98:99], s[58:59]
    v_pk_mul_f32 v[100:101], v[100:101], s[58:59]
    v_pk_mul_f32 v[102:103], v[102:103], s[58:59]
    v_pk_mul_f32 v[104:105], v[104:105], s[58:59]
    v_pk_mul_f32 v[106:107], v[106:107], s[58:59]
    v_pk_mul_f32 v[108:109], v[108:109], s[58:59]
    v_pk_mul_f32 v[110:111], v[110:111], s[58:59]
    v_mfma_f32_16x16x32_bf16 v[144:147], a[0:3], v[196:199], 0
    v_cvt_pk_bf16_f32 v212, v80, v81
    v_cvt_pk_bf16_f32 v213, v82, v83
    v_mfma_f32_16x16x32_bf16 v[148:151], a[16:19], v[196:199], 0
    v_cvt_pk_bf16_f32 v214, v84, v85
    v_cvt_pk_bf16_f32 v215, v86, v87
    v_mfma_f32_16x16x32_bf16 v[144:147], a[4:7], v[200:203], v[144:147]
    v_cvt_pk_bf16_f32 v216, v88, v89
    v_cvt_pk_bf16_f32 v217, v90, v91
    v_mfma_f32_16x16x32_bf16 v[148:151], a[20:23], v[200:203], v[148:151]
    v_cvt_pk_bf16_f32 v218, v92, v93
    v_cvt_pk_bf16_f32 v219, v94, v95
    v_mfma_f32_16x16x32_bf16 v[144:147], a[8:11], v[204:207], v[144:147]
    v_cvt_pk_bf16_f32 v220, v96, v97
    v_cvt_pk_bf16_f32 v221, v98, v99
    v_mfma_f32_16x16x32_bf16 v[148:151], a[24:27], v[204:207], v[148:151]
    v_cvt_pk_bf16_f32 v222, v100, v101
    v_cvt_pk_bf16_f32 v223, v102, v103
    v_mfma_f32_16x16x32_bf16 v[144:147], a[12:15], v[208:211], v[144:147]
    v_cvt_pk_bf16_f32 v224, v104, v105
    v_cvt_pk_bf16_f32 v225, v106, v107
    v_mfma_f32_16x16x32_bf16 v[148:151], a[28:31], v[208:211], v[148:151]
    v_cvt_pk_bf16_f32 v226, v108, v109
    v_cvt_pk_bf16_f32 v227, v110, v111
    v_mov_b64 v[80:81], 0
    v_mov_b64 v[82:83], 0
    v_mov_b64 v[84:85], 0
    v_mov_b64 v[86:87], 0
    v_mov_b64 v[88:89], 0
    v_mov_b64 v[90:91], 0
    v_mov_b64 v[92:93], 0
    v_mov_b64 v[94:95], 0
    v_mov_b64 v[96:97], 0
    v_mov_b64 v[98:99], 0
    v_mov_b64 v[100:101], 0
    v_mov_b64 v[102:103], 0
    v_mov_b64 v[104:105], 0
    v_mov_b64 v[106:107], 0
    v_mov_b64 v[108:109], 0
    v_mov_b64 v[110:111], 0
    v_permlane16_swap_b32 v212, v214
    v_permlane16_swap_b32 v213, v215
    v_permlane16_swap_b32 v216, v218
    v_permlane16_swap_b32 v217, v219
    v_permlane16_swap_b32 v220, v222
    v_permlane16_swap_b32 v221, v223
    v_permlane16_swap_b32 v224, v226
    v_permlane16_swap_b32 v225, v227
    s_nop 0
    v_mfma_f32_16x16x32_bf16 v[152:155], a[0:3], v[212:215], 0
    v_accvgpr_write_b32 a32, 0
    v_accvgpr_write_b32 a33, 0
    v_mfma_f32_16x16x32_bf16 v[156:159], a[16:19], v[212:215], 0
    v_accvgpr_write_b32 a34, 0
    v_accvgpr_write_b32 a35, 0
    v_mfma_f32_16x16x32_bf16 v[152:155], a[4:7], v[216:219], v[152:155]
    v_accvgpr_write_b32 a36, 0
    v_accvgpr_write_b32 a37, 0
    v_mfma_f32_16x16x32_bf16 v[156:159], a[20:23], v[216:219], v[156:159]
    v_accvgpr_write_b32 a38, 0
    v_accvgpr_write_b32 a39, 0
    v_mfma_f32_16x16x32_bf16 v[152:155], a[8:11], v[220:223], v[152:155]
    v_accvgpr_write_b32 a40, 0
    v_accvgpr_write_b32 a41, 0
    v_mfma_f32_16x16x32_bf16 v[156:159], a[24:27], v[220:223], v[156:159]
    v_accvgpr_write_b32 a42, 0
    v_accvgpr_write_b32 a43, 0
    v_mfma_f32_16x16x32_bf16 v[152:155], a[12:15], v[224:227], v[152:155]
    v_accvgpr_write_b32 a44, 0
    v_accvgpr_write_b32 a45, 0
    v_mfma_f32_16x16x32_bf16 v[156:159], a[28:31], v[224:227], v[156:159]
    v_accvgpr_write_b32 a46, 0
    v_accvgpr_write_b32 a47, 0
    v_max3_f32 v1, v136, v137, v138
    v_max3_f32 v1, v1, v139, v140
    v_max3_f32 v1, v1, v141, v142
    v_max_f32 v1, v1, v143
    v_mov_b32 v2, v1
    s_nop 1
    v_permlane16_swap_b32 v1, v2
    v_max_f32 v1, v1, v2
    v_mov_b32 v2, v1
    s_nop 1
    v_permlane32_swap_b32 v1, v2
    v_max_f32 v1, v1, v2
    v_add_f32 v1, 0x40e00000, v1
    v_sub_f32 v124, 0, v1
    v_sub_f32 v125, 0, v1
    v_sub_f32 v126, 0, v1
    v_sub_f32 v127, 0, v1
    v_sub_f32 v136, v136, v1
    v_sub_f32 v137, v137, v1
    v_sub_f32 v138, v138, v1
    v_sub_f32 v139, v139, v1
    v_sub_f32 v140, v140, v1
    v_sub_f32 v141, v141, v1
    v_sub_f32 v142, v142, v1
    v_sub_f32 v143, v143, v1
    v_max3_f32 v1, v144, v145, v146
    v_max3_f32 v1, v1, v147, v148
    v_max3_f32 v1, v1, v149, v150
    v_max_f32 v1, v1, v151
    v_mov_b32 v2, v1
    s_nop 1
    v_permlane16_swap_b32 v1, v2
    v_max_f32 v1, v1, v2
    v_mov_b32 v2, v1
    s_nop 1
    v_permlane32_swap_b32 v1, v2
    v_max_f32 v1, v1, v2
    v_add_f32 v1, 0x40e00000, v1
    v_sub_f32 v128, 0, v1
    v_sub_f32 v129, 0, v1
    v_sub_f32 v130, 0, v1
    v_sub_f32 v131, 0, v1
    v_accvgpr_write_b32 a48, 0
    v_accvgpr_write_b32 a49, 0
    v_accvgpr_write_b32 a50, 0
    v_accvgpr_write_b32 a51, 0
    v_accvgpr_write_b32 a52, 0
    v_accvgpr_write_b32 a53, 0
    v_accvgpr_write_b32 a54, 0
    v_accvgpr_write_b32 a55, 0
    v_accvgpr_write_b32 a56, 0
    v_accvgpr_write_b32 a57, 0
    v_accvgpr_write_b32 a58, 0
    v_accvgpr_write_b32 a59, 0
    v_accvgpr_write_b32 a60, 0
    v_accvgpr_write_b32 a61, 0
    v_accvgpr_write_b32 a62, 0
    v_accvgpr_write_b32 a63, 0
    v_max3_f32 v1, v152, v153, v154
    v_max3_f32 v1, v1, v155, v156
    v_max3_f32 v1, v1, v157, v158
    v_max_f32 v1, v1, v159
    v_mov_b32 v2, v1
    s_nop 1
    v_permlane16_swap_b32 v1, v2
    v_max_f32 v1, v1, v2
    v_mov_b32 v2, v1
    s_nop 1
    v_permlane32_swap_b32 v1, v2
    v_max_f32 v1, v1, v2
    v_add_f32 v1, 0x40e00000, v1
    v_sub_f32 v132, 0, v1
    v_sub_f32 v133, 0, v1
    v_sub_f32 v134, 0, v1
    v_sub_f32 v135, 0, v1
    v_mov_b32 v7, 1
    ds_write_b32 v6, v7
    ds_read_b32 v5, v4
    v_exp_f32 v160, v136
    v_exp_f32 v161, v137
    v_exp_f32 v162, v138
    v_exp_f32 v163, v139
    v_exp_f32 v164, v140
    v_exp_f32 v165, v141
    v_exp_f32 v166, v142
    .p2align 3
L_att:
    v_mfma_f32_16x16x32_bf16 v[144:147], a[0:3], v[196:199], v[128:131]
    v_exp_f32 v167, v143
    v_mfma_f32_16x16x32_bf16 v[148:151], a[16:19], v[196:199], v[128:131]
    s_add_u32 s71, s71, s71
    v_cvt_pk_bf16_f32 v168, v160, v161
    v_cvt_pk_bf16_f32 v169, v162, v163
    v_mfma_f32_16x16x32_bf16 v[144:147], a[4:7], v[200:203], v[144:147]
    s_cselect_b32 s72, 1, 0
    v_cvt_pk_bf16_f32 v170, v164, v165
    v_cvt_pk_bf16_f32 v171, v166, v167
    v_mfma_f32_16x16x32_bf16 v[148:151], a[20:23], v[200:203], v[148:151]
    v_or3_b32 v250, v168, v169, v170
    v_bitop3_b32 v250, v250, v171, s63 bitop3:0xa8
    v_mfma_f32_16x16x32_bf16 v[144:147], a[8:11], v[204:207], v[144:147]
    v_cmp_ne_u32 vcc, s72, v250
    v_xor_b32 v236, s68, v236
    v_mfma_f32_16x16x32_bf16 v[148:151], a[24:27], v[204:207], v[148:151]
    s_waitcnt lgkmcnt(0)
    v_xor_b32 v232, s68, v232
    v_mfma_f32_16x16x32_bf16 v[144:147], a[12:15], v[208:211], v[144:147]
    s_cbranch_vccnz L_stub0
L_ret0:
    v_cmp_gt_u32 vcc, s62, v5
    v_xor_b32 v233, s68, v233
    v_mfma_f32_16x16x32_bf16 v[148:151], a[28:31], v[208:211], v[148:151]
    v_xor_b32 v234, s68, v234
    v_xor_b32 v235, s68, v235
    v_mfma_f32_16x16x32_bf16 v[80:83], a[32:35], v[176:179], v[80:83]
    s_cbranch_vccnz L_stub3
L_ret3:
    ds_read_b64_tr_b16 a[32:33], v232 offset:0
    v_add_u32 v7, 1, v7
    v_mfma_f32_16x16x32_bf16 v[84:87], a[36:39], v[176:179], v[84:87]
    s_add_u32 s70, s70, s70
    ds_read_b64_tr_b16 a[34:35], v232 offset:4096
    ds_read_b64_tr_b16 a[36:37], v233 offset:0
    v_mfma_f32_16x16x32_bf16 v[88:91], a[40:43], v[176:179], v[88:91]
    s_addc_u32 s62, s62, 0
    ds_read_b64_tr_b16 a[38:39], v233 offset:4096
    ds_read_b64_tr_b16 a[40:41], v234 offset:0
    v_mfma_f32_16x16x32_bf16 v[92:95], a[44:47], v[176:179], v[92:95]
    v_exp_f32 v160, v144
    v_xor_b32 v237, s68, v237
    v_mfma_f32_16x16x32_bf16 v[96:99], a[48:51], v[176:179], v[96:99]
    ds_read_b64_tr_b16 a[42:43], v234 offset:4096
    ds_read_b64_tr_b16 a[44:45], v235 offset:0
    v_mfma_f32_16x16x32_bf16 v[100:103], a[52:55], v[176:179], v[100:103]
    v_exp_f32 v161, v145
    v_xor_b32 v238, s68, v238
    v_mfma_f32_16x16x32_bf16 v[104:107], a[56:59], v[176:179], v[104:107]
    ds_read_b64_tr_b16 a[46:47], v235 offset:4096
    ds_read_b64_tr_b16 a[48:49], v236 offset:0
    v_mfma_f32_16x16x32_bf16 v[108:111], a[60:63], v[176:179], v[108:111]
    v_exp_f32 v162, v146
    v_xor_b32 v239, s68, v239
    v_mfma_f32_16x16x32_bf16 v[120:123], v[252:255], v[176:179], v[120:123]
    ds_read_b64_tr_b16 a[50:51], v236 offset:4096
    ds_read_b64_tr_b16 a[52:53], v237 offset:0
    v_mfma_f32_16x16x32_bf16 v[152:155], a[0:3], v[212:215], v[132:135]
    v_exp_f32 v163, v147
    v_mfma_f32_16x16x32_bf16 v[156:159], a[16:19], v[212:215], v[132:135]
    ds_read_b64_tr_b16 a[54:55], v237 offset:4096
    v_cvt_pk_bf16_f32 v172, v160, v161
    v_mfma_f32_16x16x32_bf16 v[152:155], a[4:7], v[216:219], v[152:155]
    ds_read_b64_tr_b16 a[56:57], v238 offset:0
    v_cvt_pk_bf16_f32 v173, v162, v163
    v_mfma_f32_16x16x32_bf16 v[156:159], a[20:23], v[216:219], v[156:159]
    v_exp_f32 v164, v148
    v_mfma_f32_16x16x32_bf16 v[152:155], a[8:11], v[220:223], v[152:155]
    ds_read_b64_tr_b16 a[58:59], v238 offset:4096
    ds_read_b64_tr_b16 a[60:61], v239 offset:0
    v_mfma_f32_16x16x32_bf16 v[156:159], a[24:27], v[220:223], v[156:159]
    v_exp_f32 v165, v149
    v_mfma_f32_16x16x32_bf16 v[152:155], a[12:15], v[224:227], v[152:155]
    ds_read_b64_tr_b16 a[62:63], v239 offset:4096
    ds_read_b128 a[0:3], v228 offset:16384
    v_mfma_f32_16x16x32_bf16 v[156:159], a[28:31], v[224:227], v[156:159]
    s_waitcnt lgkmcnt(5)
    v_exp_f32 v166, v150
    v_mfma_f32_16x16x32_bf16 v[16:19], a[32:35], v[168:171], v[16:19]
    ds_read_b128 a[16:19], v228 offset:20480
    ds_read_b128 a[4:7], v229 offset:16384
    v_mfma_f32_16x16x32_bf16 v[20:23], a[36:39], v[168:171], v[20:23]
    v_exp_f32 v167, v151
    v_mfma_f32_16x16x32_bf16 v[24:27], a[40:43], v[168:171], v[24:27]
    s_add_u32 s71, s71, s71
    ds_read_b128 a[20:23], v229 offset:20480
    v_cvt_pk_bf16_f32 v174, v164, v165
    v_mfma_f32_16x16x32_bf16 v[28:31], a[44:47], v[168:171], v[28:31]
    s_cselect_b32 s72, 1, 0
    ds_read_b128 a[8:11], v230 offset:16384
    v_cvt_pk_bf16_f32 v175, v166, v167
    v_mfma_f32_16x16x32_bf16 v[32:35], a[48:51], v[168:171], v[32:35]
    ds_read_b128 a[24:27], v230 offset:20480
    v_or3_b32 v250, v172, v173, v174
    v_mfma_f32_16x16x32_bf16 v[36:39], a[52:55], v[168:171], v[36:39]
    s_waitcnt lgkmcnt(6)
    ds_read_b128 a[12:15], v231 offset:16384
    v_bitop3_b32 v250, v250, v175, s63 bitop3:0xa8
    v_mfma_f32_16x16x32_bf16 v[40:43], a[56:59], v[168:171], v[40:43]
    ds_read_b128 a[28:31], v231 offset:20480
    v_cmp_ne_u32 vcc, s72, v250
    v_mfma_f32_16x16x32_bf16 v[44:47], a[60:63], v[168:171], v[44:47]
    v_exp_f32 v160, v152
    v_mfma_f32_16x16x32_bf16 v[112:115], v[252:255], v[168:171], v[112:115]
    s_cbranch_vccnz L_stub1
L_ret1:
    s_waitcnt lgkmcnt(4)
    v_exp_f32 v161, v153
    v_mfma_f32_16x16x32_bf16 v[136:139], a[0:3], v[180:183], v[124:127]
    v_exp_f32 v162, v154
    v_mfma_f32_16x16x32_bf16 v[140:143], a[16:19], v[180:183], v[124:127]
    v_exp_f32 v163, v155
    v_mfma_f32_16x16x32_bf16 v[136:139], a[4:7], v[184:187], v[136:139]
    v_exp_f32 v164, v156
    v_mfma_f32_16x16x32_bf16 v[140:143], a[20:23], v[184:187], v[140:143]
    s_waitcnt lgkmcnt(0)
    v_exp_f32 v165, v157
    v_mfma_f32_16x16x32_bf16 v[136:139], a[8:11], v[188:191], v[136:139]
    v_exp_f32 v166, v158
    v_mfma_f32_16x16x32_bf16 v[140:143], a[24:27], v[188:191], v[140:143]
    v_exp_f32 v167, v159
    v_mfma_f32_16x16x32_bf16 v[136:139], a[12:15], v[192:195], v[136:139]
    s_add_u32 s71, s71, s71
    ds_write_b32 v6, v7
    v_cvt_pk_bf16_f32 v176, v160, v161
    v_mfma_f32_16x16x32_bf16 v[140:143], a[28:31], v[192:195], v[140:143]
    s_cselect_b32 s72, 1, 0
    v_cvt_pk_bf16_f32 v177, v162, v163
    v_cvt_pk_bf16_f32 v178, v164, v165
    v_mfma_f32_16x16x32_bf16 v[48:51], a[32:35], v[172:175], v[48:51]
    v_cvt_pk_bf16_f32 v179, v166, v167
    v_or3_b32 v250, v176, v177, v178
    v_mfma_f32_16x16x32_bf16 v[52:55], a[36:39], v[172:175], v[52:55]
    ds_read_b32 v5, v4
    v_bitop3_b32 v250, v250, v179, s63 bitop3:0xa8
    v_mfma_f32_16x16x32_bf16 v[56:59], a[40:43], v[172:175], v[56:59]
    v_cmp_ne_u32 vcc, s72, v250
    v_exp_f32 v160, v136
    v_mfma_f32_16x16x32_bf16 v[60:63], a[44:47], v[172:175], v[60:63]
    v_exp_f32 v161, v137
    v_mfma_f32_16x16x32_bf16 v[64:67], a[48:51], v[172:175], v[64:67]
    s_cbranch_vccnz L_stub2
L_ret2:
    v_exp_f32 v162, v138
    v_mfma_f32_16x16x32_bf16 v[68:71], a[52:55], v[172:175], v[68:71]
    v_exp_f32 v163, v139
    v_mfma_f32_16x16x32_bf16 v[72:75], a[56:59], v[172:175], v[72:75]
    v_exp_f32 v164, v140
    v_mfma_f32_16x16x32_bf16 v[76:79], a[60:63], v[172:175], v[76:79]
    v_exp_f32 v165, v141
    v_mfma_f32_16x16x32_bf16 v[116:119], v[252:255], v[172:175], v[116:119]
    v_exp_f32 v166, v142
    v_mfma_f32_16x16x32_bf16 v[144:147], a[0:3], v[196:199], v[128:131]
    s_cmp_gt_u32 s60, 4
    v_exp_f32 v167, v143
    v_mfma_f32_16x16x32_bf16 v[148:151], a[16:19], v[196:199], v[128:131]
    s_cselect_b32 s68, s68, 0
    s_add_u32 s71, s71, s71
    v_cvt_pk_bf16_f32 v168, v160, v161
    v_cvt_pk_bf16_f32 v169, v162, v163
    v_mfma_f32_16x16x32_bf16 v[144:147], a[4:7], v[200:203], v[144:147]
    s_cselect_b32 s72, 1, 0
    v_cvt_pk_bf16_f32 v170, v164, v165
    v_cvt_pk_bf16_f32 v171, v166, v167
    v_mfma_f32_16x16x32_bf16 v[148:151], a[20:23], v[200:203], v[148:151]
    v_or3_b32 v250, v168, v169, v170
    v_bitop3_b32 v250, v250, v171, s63 bitop3:0xa8
    v_mfma_f32_16x16x32_bf16 v[144:147], a[8:11], v[204:207], v[144:147]
    v_cmp_ne_u32 vcc, s72, v250
    v_mfma_f32_16x16x32_bf16 v[148:151], a[24:27], v[204:207], v[148:151]
    s_waitcnt lgkmcnt(0)
    v_mfma_f32_16x16x32_bf16 v[144:147], a[12:15], v[208:211], v[144:147]
    s_cbranch_vccnz L_stub4
L_ret4:
    v_cmp_gt_u32 vcc, s62, v5
    v_mfma_f32_16x16x32_bf16 v[148:151], a[28:31], v[208:211], v[148:151]
    v_mfma_f32_16x16x32_bf16 v[80:83], a[32:35], v[176:179], v[80:83]
    s_cbranch_vccnz L_stub7
L_ret7:
    ds_read_b64_tr_b16 a[32:33], v232 offset:16384
    v_add_u32 v7, 1, v7
    v_mfma_f32_16x16x32_bf16 v[84:87], a[36:39], v[176:179], v[84:87]
    s_add_u32 s70, s70, s70
    ds_read_b64_tr_b16 a[34:35], v232 offset:20480
    ds_read_b64_tr_b16 a[36:37], v233 offset:16384
    v_mfma_f32_16x16x32_bf16 v[88:91], a[40:43], v[176:179], v[88:91]
    s_addc_u32 s62, s62, 0
    ds_read_b64_tr_b16 a[38:39], v233 offset:20480
    ds_read_b64_tr_b16 a[40:41], v234 offset:16384
    v_mfma_f32_16x16x32_bf16 v[92:95], a[44:47], v[176:179], v[92:95]
    v_exp_f32 v160, v144
    v_mfma_f32_16x16x32_bf16 v[96:99], a[48:51], v[176:179], v[96:99]
    ds_read_b64_tr_b16 a[42:43], v234 offset:20480
    ds_read_b64_tr_b16 a[44:45], v235 offset:16384
    v_mfma_f32_16x16x32_bf16 v[100:103], a[52:55], v[176:179], v[100:103]
    v_exp_f32 v161, v145
    v_mfma_f32_16x16x32_bf16 v[104:107], a[56:59], v[176:179], v[104:107]
    ds_read_b64_tr_b16 a[46:47], v235 offset:20480
    ds_read_b64_tr_b16 a[48:49], v236 offset:16384
    v_mfma_f32_16x16x32_bf16 v[108:111], a[60:63], v[176:179], v[108:111]
    v_exp_f32 v162, v146
    v_mfma_f32_16x16x32_bf16 v[120:123], v[252:255], v[176:179], v[120:123]
    ds_read_b64_tr_b16 a[50:51], v236 offset:20480
    ds_read_b64_tr_b16 a[52:53], v237 offset:16384
    v_mfma_f32_16x16x32_bf16 v[152:155], a[0:3], v[212:215], v[132:135]
    v_exp_f32 v163, v147
    v_mfma_f32_16x16x32_bf16 v[156:159], a[16:19], v[212:215], v[132:135]
    ds_read_b64_tr_b16 a[54:55], v237 offset:20480
    v_cvt_pk_bf16_f32 v172, v160, v161
    v_mfma_f32_16x16x32_bf16 v[152:155], a[4:7], v[216:219], v[152:155]
    ds_read_b64_tr_b16 a[56:57], v238 offset:16384
    v_cvt_pk_bf16_f32 v173, v162, v163
    v_mfma_f32_16x16x32_bf16 v[156:159], a[20:23], v[216:219], v[156:159]
    v_exp_f32 v164, v148
    v_mfma_f32_16x16x32_bf16 v[152:155], a[8:11], v[220:223], v[152:155]
    ds_read_b64_tr_b16 a[58:59], v238 offset:20480
    ds_read_b64_tr_b16 a[60:61], v239 offset:16384
    v_mfma_f32_16x16x32_bf16 v[156:159], a[24:27], v[220:223], v[156:159]
    v_exp_f32 v165, v149
    v_mfma_f32_16x16x32_bf16 v[152:155], a[12:15], v[224:227], v[152:155]
    ds_read_b64_tr_b16 a[62:63], v239 offset:20480
    ds_read_b128 a[0:3], v228 offset:32768
    v_mfma_f32_16x16x32_bf16 v[156:159], a[28:31], v[224:227], v[156:159]
    s_waitcnt lgkmcnt(5)
    v_exp_f32 v166, v150
    v_mfma_f32_16x16x32_bf16 v[16:19], a[32:35], v[168:171], v[16:19]
    ds_read_b128 a[16:19], v228 offset:36864
    ds_read_b128 a[4:7], v229 offset:32768
    v_mfma_f32_16x16x32_bf16 v[20:23], a[36:39], v[168:171], v[20:23]
    v_exp_f32 v167, v151
    v_mfma_f32_16x16x32_bf16 v[24:27], a[40:43], v[168:171], v[24:27]
    s_add_u32 s71, s71, s71
    ds_read_b128 a[20:23], v229 offset:36864
    v_cvt_pk_bf16_f32 v174, v164, v165
    v_mfma_f32_16x16x32_bf16 v[28:31], a[44:47], v[168:171], v[28:31]
    s_cselect_b32 s72, 1, 0
    ds_read_b128 a[8:11], v230 offset:32768
    v_cvt_pk_bf16_f32 v175, v166, v167
    v_mfma_f32_16x16x32_bf16 v[32:35], a[48:51], v[168:171], v[32:35]
    ds_read_b128 a[24:27], v230 offset:36864
    v_or3_b32 v250, v172, v173, v174
    v_mfma_f32_16x16x32_bf16 v[36:39], a[52:55], v[168:171], v[36:39]
    s_waitcnt lgkmcnt(6)
    ds_read_b128 a[12:15], v231 offset:32768
    v_bitop3_b32 v250, v250, v175, s63 bitop3:0xa8
    v_mfma_f32_16x16x32_bf16 v[40:43], a[56:59], v[168:171], v[40:43]
    ds_read_b128 a[28:31], v231 offset:36864
    v_cmp_ne_u32 vcc, s72, v250
    v_mfma_f32_16x16x32_bf16 v[44:47], a[60:63], v[168:171], v[44:47]
    v_exp_f32 v160, v152
    v_mfma_f32_16x16x32_bf16 v[112:115], v[252:255], v[168:171], v[112:115]
    s_cbranch_vccnz L_stub5
L_ret5:
    s_waitcnt lgkmcnt(4)
    v_exp_f32 v161, v153
    v_mfma_f32_16x16x32_bf16 v[136:139], a[0:3], v[180:183], v[124:127]
    v_exp_f32 v162, v154
    v_mfma_f32_16x16x32_bf16 v[140:143], a[16:19], v[180:183], v[124:127]
    v_exp_f32 v163, v155
    v_mfma_f32_16x16x32_bf16 v[136:139], a[4:7], v[184:187], v[136:139]
    v_exp_f32 v164, v156
    v_mfma_f32_16x16x32_bf16 v[140:143], a[20:23], v[184:187], v[140:143]
    s_waitcnt lgkmcnt(0)
    v_exp_f32 v165, v157
    v_mfma_f32_16x16x32_bf16 v[136:139], a[8:11], v[188:191], v[136:139]
    v_exp_f32 v166, v158
    v_mfma_f32_16x16x32_bf16 v[140:143], a[24:27], v[188:191], v[140:143]
    v_exp_f32 v167, v159
    v_mfma_f32_16x16x32_bf16 v[136:139], a[12:15], v[192:195], v[136:139]
    s_add_u32 s71, s71, s71
    ds_write_b32 v6, v7
    v_cvt_pk_bf16_f32 v176, v160, v161
    v_mfma_f32_16x16x32_bf16 v[140:143], a[28:31], v[192:195], v[140:143]
    s_cselect_b32 s72, 1, 0
    v_cvt_pk_bf16_f32 v177, v162, v163
    v_cvt_pk_bf16_f32 v178, v164, v165
    v_mfma_f32_16x16x32_bf16 v[48:51], a[32:35], v[172:175], v[48:51]
    v_cvt_pk_bf16_f32 v179, v166, v167
    v_or3_b32 v250, v176, v177, v178
    v_mfma_f32_16x16x32_bf16 v[52:55], a[36:39], v[172:175], v[52:55]
    ds_read_b32 v5, v4
    v_bitop3_b32 v250, v250, v179, s63 bitop3:0xa8
    v_mfma_f32_16x16x32_bf16 v[56:59], a[40:43], v[172:175], v[56:59]
    v_cmp_ne_u32 vcc, s72, v250
    v_exp_f32 v160, v136
    v_mfma_f32_16x16x32_bf16 v[60:63], a[44:47], v[172:175], v[60:63]
    v_exp_f32 v161, v137
    v_mfma_f32_16x16x32_bf16 v[64:67], a[48:51], v[172:175], v[64:67]
    s_cbranch_vccnz L_stub6
L_ret6:
    v_exp_f32 v162, v138
    v_mfma_f32_16x16x32_bf16 v[68:71], a[52:55], v[172:175], v[68:71]
    v_exp_f32 v163, v139
    v_mfma_f32_16x16x32_bf16 v[72:75], a[56:59], v[172:175], v[72:75]
    v_exp_f32 v164, v140
    v_mfma_f32_16x16x32_bf16 v[76:79], a[60:63], v[172:175], v[76:79]
    v_exp_f32 v165, v141
    v_mfma_f32_16x16x32_bf16 v[116:119], v[252:255], v[172:175], v[116:119]
    v_exp_f32 v166, v142
    v_mfma_f32_16x16x32_bf16 v[144:147], a[0:3], v[196:199], v[128:131]
    v_exp_f32 v167, v143
    v_mfma_f32_16x16x32_bf16 v[148:151], a[16:19], v[196:199], v[128:131]
    s_add_u32 s71, s71, s71
    v_cvt_pk_bf16_f32 v168, v160, v161
    v_cvt_pk_bf16_f32 v169, v162, v163
    v_mfma_f32_16x16x32_bf16 v[144:147], a[4:7], v[200:203], v[144:147]
    s_cselect_b32 s72, 1, 0
    v_cvt_pk_bf16_f32 v170, v164, v165
    v_cvt_pk_bf16_f32 v171, v166, v167
    v_mfma_f32_16x16x32_bf16 v[148:151], a[20:23], v[200:203], v[148:151]
    v_or3_b32 v250, v168, v169, v170
    v_bitop3_b32 v250, v250, v171, s63 bitop3:0xa8
    v_mfma_f32_16x16x32_bf16 v[144:147], a[8:11], v[204:207], v[144:147]
    v_cmp_ne_u32 vcc, s72, v250
    v_mfma_f32_16x16x32_bf16 v[148:151], a[24:27], v[204:207], v[148:151]
    s_waitcnt lgkmcnt(0)
    v_mfma_f32_16x16x32_bf16 v[144:147], a[12:15], v[208:211], v[144:147]
    s_cbranch_vccnz L_stub8
L_ret8:
    v_cmp_gt_u32 vcc, s62, v5
    v_mfma_f32_16x16x32_bf16 v[148:151], a[28:31], v[208:211], v[148:151]
    v_mfma_f32_16x16x32_bf16 v[80:83], a[32:35], v[176:179], v[80:83]
    s_cbranch_vccnz L_stub11
L_ret11:
    ds_read_b64_tr_b16 a[32:33], v232 offset:32768
    v_add_u32 v7, 1, v7
    v_mfma_f32_16x16x32_bf16 v[84:87], a[36:39], v[176:179], v[84:87]
    s_add_u32 s70, s70, s70
    ds_read_b64_tr_b16 a[34:35], v232 offset:36864
    ds_read_b64_tr_b16 a[36:37], v233 offset:32768
    v_mfma_f32_16x16x32_bf16 v[88:91], a[40:43], v[176:179], v[88:91]
    s_addc_u32 s62, s62, 0
    ds_read_b64_tr_b16 a[38:39], v233 offset:36864
    ds_read_b64_tr_b16 a[40:41], v234 offset:32768
    v_mfma_f32_16x16x32_bf16 v[92:95], a[44:47], v[176:179], v[92:95]
    v_exp_f32 v160, v144
    v_mfma_f32_16x16x32_bf16 v[96:99], a[48:51], v[176:179], v[96:99]
    ds_read_b64_tr_b16 a[42:43], v234 offset:36864
    ds_read_b64_tr_b16 a[44:45], v235 offset:32768
    v_mfma_f32_16x16x32_bf16 v[100:103], a[52:55], v[176:179], v[100:103]
    v_exp_f32 v161, v145
    v_mfma_f32_16x16x32_bf16 v[104:107], a[56:59], v[176:179], v[104:107]
    ds_read_b64_tr_b16 a[46:47], v235 offset:36864
    ds_read_b64_tr_b16 a[48:49], v236 offset:32768
    v_mfma_f32_16x16x32_bf16 v[108:111], a[60:63], v[176:179], v[108:111]
    v_exp_f32 v162, v146
    v_mfma_f32_16x16x32_bf16 v[120:123], v[252:255], v[176:179], v[120:123]
    ds_read_b64_tr_b16 a[50:51], v236 offset:36864
    ds_read_b64_tr_b16 a[52:53], v237 offset:32768
    v_mfma_f32_16x16x32_bf16 v[152:155], a[0:3], v[212:215], v[132:135]
    v_exp_f32 v163, v147
    v_mfma_f32_16x16x32_bf16 v[156:159], a[16:19], v[212:215], v[132:135]
    ds_read_b64_tr_b16 a[54:55], v237 offset:36864
    v_cvt_pk_bf16_f32 v172, v160, v161
    v_mfma_f32_16x16x32_bf16 v[152:155], a[4:7], v[216:219], v[152:155]
    ds_read_b64_tr_b16 a[56:57], v238 offset:32768
    v_cvt_pk_bf16_f32 v173, v162, v163
    v_mfma_f32_16x16x32_bf16 v[156:159], a[20:23], v[216:219], v[156:159]
    v_exp_f32 v164, v148
    v_mfma_f32_16x16x32_bf16 v[152:155], a[8:11], v[220:223], v[152:155]
    ds_read_b64_tr_b16 a[58:59], v238 offset:36864
    ds_read_b64_tr_b16 a[60:61], v239 offset:32768
    v_mfma_f32_16x16x32_bf16 v[156:159], a[24:27], v[220:223], v[156:159]
    v_exp_f32 v165, v149
    v_mfma_f32_16x16x32_bf16 v[152:155], a[12:15], v[224:227], v[152:155]
    ds_read_b64_tr_b16 a[62:63], v239 offset:36864
    ds_read_b128 a[0:3], v228 offset:49152
    v_mfma_f32_16x16x32_bf16 v[156:159], a[28:31], v[224:227], v[156:159]
    s_waitcnt lgkmcnt(5)
    v_exp_f32 v166, v150
    v_mfma_f32_16x16x32_bf16 v[16:19], a[32:35], v[168:171], v[16:19]
    ds_read_b128 a[16:19], v228 offset:53248
    ds_read_b128 a[4:7], v229 offset:49152
    v_mfma_f32_16x16x32_bf16 v[20:23], a[36:39], v[168:171], v[20:23]
    v_exp_f32 v167, v151
    v_mfma_f32_16x16x32_bf16 v[24:27], a[40:43], v[168:171], v[24:27]
    s_add_u32 s71, s71, s71
    ds_read_b128 a[20:23], v229 offset:53248
    v_cvt_pk_bf16_f32 v174, v164, v165
    v_mfma_f32_16x16x32_bf16 v[28:31], a[44:47], v[168:171], v[28:31]
    s_cselect_b32 s72, 1, 0
    ds_read_b128 a[8:11], v230 offset:49152
    v_cvt_pk_bf16_f32 v175, v166, v167
    v_mfma_f32_16x16x32_bf16 v[32:35], a[48:51], v[168:171], v[32:35]
    ds_read_b128 a[24:27], v230 offset:53248
    v_or3_b32 v250, v172, v173, v174
    v_mfma_f32_16x16x32_bf16 v[36:39], a[52:55], v[168:171], v[36:39]
    s_waitcnt lgkmcnt(6)
    ds_read_b128 a[12:15], v231 offset:49152
    v_bitop3_b32 v250, v250, v175, s63 bitop3:0xa8
    v_mfma_f32_16x16x32_bf16 v[40:43], a[56:59], v[168:171], v[40:43]
    ds_read_b128 a[28:31], v231 offset:53248
    v_cmp_ne_u32 vcc, s72, v250
    v_mfma_f32_16x16x32_bf16 v[44:47], a[60:63], v[168:171], v[44:47]
    v_exp_f32 v160, v152
    v_mfma_f32_16x16x32_bf16 v[112:115], v[252:255], v[168:171], v[112:115]
    s_cbranch_vccnz L_stub9
L_ret9:
    s_waitcnt lgkmcnt(4)
    v_exp_f32 v161, v153
    v_mfma_f32_16x16x32_bf16 v[136:139], a[0:3], v[180:183], v[124:127]
    v_exp_f32 v162, v154
    v_mfma_f32_16x16x32_bf16 v[140:143], a[16:19], v[180:183], v[124:127]
    v_exp_f32 v163, v155
    v_mfma_f32_16x16x32_bf16 v[136:139], a[4:7], v[184:187], v[136:139]
    v_exp_f32 v164, v156
    v_mfma_f32_16x16x32_bf16 v[140:143], a[20:23], v[184:187], v[140:143]
    s_waitcnt lgkmcnt(0)
    v_exp_f32 v165, v157
    v_mfma_f32_16x16x32_bf16 v[136:139], a[8:11], v[188:191], v[136:139]
    v_exp_f32 v166, v158
    v_mfma_f32_16x16x32_bf16 v[140:143], a[24:27], v[188:191], v[140:143]
    v_exp_f32 v167, v159
    v_mfma_f32_16x16x32_bf16 v[136:139], a[12:15], v[192:195], v[136:139]
    s_add_u32 s71, s71, s71
    ds_write_b32 v6, v7
    v_cvt_pk_bf16_f32 v176, v160, v161
    v_mfma_f32_16x16x32_bf16 v[140:143], a[28:31], v[192:195], v[140:143]
    s_cselect_b32 s72, 1, 0
    v_cvt_pk_bf16_f32 v177, v162, v163
    v_cvt_pk_bf16_f32 v178, v164, v165
    v_mfma_f32_16x16x32_bf16 v[48:51], a[32:35], v[172:175], v[48:51]
    v_cvt_pk_bf16_f32 v179, v166, v167
    v_or3_b32 v250, v176, v177, v178
    v_mfma_f32_16x16x32_bf16 v[52:55], a[36:39], v[172:175], v[52:55]
    ds_read_b32 v5, v4
    v_bitop3_b32 v250, v250, v179, s63 bitop3:0xa8
    v_mfma_f32_16x16x32_bf16 v[56:59], a[40:43], v[172:175], v[56:59]
    v_cmp_ne_u32 vcc, s72, v250
    v_exp_f32 v160, v136
    v_mfma_f32_16x16x32_bf16 v[60:63], a[44:47], v[172:175], v[60:63]
    v_exp_f32 v161, v137
    v_mfma_f32_16x16x32_bf16 v[64:67], a[48:51], v[172:175], v[64:67]
    s_cbranch_vccnz L_stub10
L_ret10:
    v_exp_f32 v162, v138
    v_mfma_f32_16x16x32_bf16 v[68:71], a[52:55], v[172:175], v[68:71]
    v_exp_f32 v163, v139
    v_mfma_f32_16x16x32_bf16 v[72:75], a[56:59], v[172:175], v[72:75]
    v_exp_f32 v164, v140
    v_mfma_f32_16x16x32_bf16 v[76:79], a[60:63], v[172:175], v[76:79]
    v_exp_f32 v165, v141
    v_mfma_f32_16x16x32_bf16 v[116:119], v[252:255], v[172:175], v[116:119]
    v_exp_f32 v166, v142
    v_mfma_f32_16x16x32_bf16 v[144:147], a[0:3], v[196:199], v[128:131]
    v_exp_f32 v167, v143
    v_mfma_f32_16x16x32_bf16 v[148:151], a[16:19], v[196:199], v[128:131]
    s_add_u32 s71, s71, s71
    v_cvt_pk_bf16_f32 v168, v160, v161
    v_cvt_pk_bf16_f32 v169, v162, v163
    v_mfma_f32_16x16x32_bf16 v[144:147], a[4:7], v[200:203], v[144:147]
    s_cselect_b32 s72, 1, 0
    v_cvt_pk_bf16_f32 v170, v164, v165
    v_cvt_pk_bf16_f32 v171, v166, v167
    v_mfma_f32_16x16x32_bf16 v[148:151], a[20:23], v[200:203], v[148:151]
    v_or3_b32 v250, v168, v169, v170
    v_bitop3_b32 v250, v250, v171, s63 bitop3:0xa8
    v_mfma_f32_16x16x32_bf16 v[144:147], a[8:11], v[204:207], v[144:147]
    v_cmp_ne_u32 vcc, s72, v250
    v_mfma_f32_16x16x32_bf16 v[148:151], a[24:27], v[204:207], v[148:151]
    s_waitcnt lgkmcnt(0)
    v_xor_b32 v228, s68, v228
    v_mfma_f32_16x16x32_bf16 v[144:147], a[12:15], v[208:211], v[144:147]
    s_cbranch_vccnz L_stub12
L_ret12:
    v_cmp_gt_u32 vcc, s62, v5
    v_xor_b32 v229, s68, v229
    v_mfma_f32_16x16x32_bf16 v[148:151], a[28:31], v[208:211], v[148:151]
    v_xor_b32 v230, s68, v230
    v_xor_b32 v231, s68, v231
    v_mfma_f32_16x16x32_bf16 v[80:83], a[32:35], v[176:179], v[80:83]
    s_cbranch_vccnz L_stub15
L_ret15:
    ds_read_b64_tr_b16 a[32:33], v232 offset:49152
    v_add_u32 v7, 1, v7
    v_mfma_f32_16x16x32_bf16 v[84:87], a[36:39], v[176:179], v[84:87]
    s_add_u32 s70, s70, s70
    ds_read_b64_tr_b16 a[34:35], v232 offset:53248
    ds_read_b64_tr_b16 a[36:37], v233 offset:49152
    v_mfma_f32_16x16x32_bf16 v[88:91], a[40:43], v[176:179], v[88:91]
    s_addc_u32 s62, s62, 0
    ds_read_b64_tr_b16 a[38:39], v233 offset:53248
    ds_read_b64_tr_b16 a[40:41], v234 offset:49152
    v_mfma_f32_16x16x32_bf16 v[92:95], a[44:47], v[176:179], v[92:95]
    v_exp_f32 v160, v144
    v_mfma_f32_16x16x32_bf16 v[96:99], a[48:51], v[176:179], v[96:99]
    ds_read_b64_tr_b16 a[42:43], v234 offset:53248
    ds_read_b64_tr_b16 a[44:45], v235 offset:49152
    v_mfma_f32_16x16x32_bf16 v[100:103], a[52:55], v[176:179], v[100:103]
    v_exp_f32 v161, v145
    v_mfma_f32_16x16x32_bf16 v[104:107], a[56:59], v[176:179], v[104:107]
    ds_read_b64_tr_b16 a[46:47], v235 offset:53248
    ds_read_b64_tr_b16 a[48:49], v236 offset:49152
    v_mfma_f32_16x16x32_bf16 v[108:111], a[60:63], v[176:179], v[108:111]
    v_exp_f32 v162, v146
    v_mfma_f32_16x16x32_bf16 v[120:123], v[252:255], v[176:179], v[120:123]
    ds_read_b64_tr_b16 a[50:51], v236 offset:53248
    ds_read_b64_tr_b16 a[52:53], v237 offset:49152
    v_mfma_f32_16x16x32_bf16 v[152:155], a[0:3], v[212:215], v[132:135]
    v_exp_f32 v163, v147
    v_mfma_f32_16x16x32_bf16 v[156:159], a[16:19], v[212:215], v[132:135]
    ds_read_b64_tr_b16 a[54:55], v237 offset:53248
    v_cvt_pk_bf16_f32 v172, v160, v161
    v_mfma_f32_16x16x32_bf16 v[152:155], a[4:7], v[216:219], v[152:155]
    ds_read_b64_tr_b16 a[56:57], v238 offset:49152
    v_cvt_pk_bf16_f32 v173, v162, v163
    v_mfma_f32_16x16x32_bf16 v[156:159], a[20:23], v[216:219], v[156:159]
    v_exp_f32 v164, v148
    v_mfma_f32_16x16x32_bf16 v[152:155], a[8:11], v[220:223], v[152:155]
    ds_read_b64_tr_b16 a[58:59], v238 offset:53248
    ds_read_b64_tr_b16 a[60:61], v239 offset:49152
    v_mfma_f32_16x16x32_bf16 v[156:159], a[24:27], v[220:223], v[156:159]
    v_exp_f32 v165, v149
    v_mfma_f32_16x16x32_bf16 v[152:155], a[12:15], v[224:227], v[152:155]
    ds_read_b64_tr_b16 a[62:63], v239 offset:53248
    ds_read_b128 a[0:3], v228 offset:0
    v_mfma_f32_16x16x32_bf16 v[156:159], a[28:31], v[224:227], v[156:159]
    s_waitcnt lgkmcnt(5)
    v_exp_f32 v166, v150
    v_mfma_f32_16x16x32_bf16 v[16:19], a[32:35], v[168:171], v[16:19]
    ds_read_b128 a[16:19], v228 offset:4096
    ds_read_b128 a[4:7], v229 offset:0
    v_mfma_f32_16x16x32_bf16 v[20:23], a[36:39], v[168:171], v[20:23]
    v_exp_f32 v167, v151
    v_mfma_f32_16x16x32_bf16 v[24:27], a[40:43], v[168:171], v[24:27]
    s_add_u32 s71, s71, s71
    ds_read_b128 a[20:23], v229 offset:4096
    v_cvt_pk_bf16_f32 v174, v164, v165
    v_mfma_f32_16x16x32_bf16 v[28:31], a[44:47], v[168:171], v[28:31]
    s_cselect_b32 s72, 1, 0
    ds_read_b128 a[8:11], v230 offset:0
    v_cvt_pk_bf16_f32 v175, v166, v167
    v_mfma_f32_16x16x32_bf16 v[32:35], a[48:51], v[168:171], v[32:35]
    ds_read_b128 a[24:27], v230 offset:4096
    v_or3_b32 v250, v172, v173, v174
    v_mfma_f32_16x16x32_bf16 v[36:39], a[52:55], v[168:171], v[36:39]
    s_waitcnt lgkmcnt(6)
    ds_read_b128 a[12:15], v231 offset:0
    v_bitop3_b32 v250, v250, v175, s63 bitop3:0xa8
    v_mfma_f32_16x16x32_bf16 v[40:43], a[56:59], v[168:171], v[40:43]
    s_sub_u32 s60, s60, 1
    ds_read_b128 a[28:31], v231 offset:4096
    v_cmp_ne_u32 vcc, s72, v250
    v_mfma_f32_16x16x32_bf16 v[44:47], a[60:63], v[168:171], v[44:47]
    v_exp_f32 v160, v152
    v_mfma_f32_16x16x32_bf16 v[112:115], v[252:255], v[168:171], v[112:115]
    s_cbranch_vccnz L_stub13
L_ret13:
    s_cmp_eq_u32 s60, 0
    s_cbranch_scc1 L_att_tail
    s_waitcnt lgkmcnt(4)
    v_exp_f32 v161, v153
    v_mfma_f32_16x16x32_bf16 v[136:139], a[0:3], v[180:183], v[124:127]
    v_exp_f32 v162, v154
    v_mfma_f32_16x16x32_bf16 v[140:143], a[16:19], v[180:183], v[124:127]
    v_exp_f32 v163, v155
    v_mfma_f32_16x16x32_bf16 v[136:139], a[4:7], v[184:187], v[136:139]
    v_exp_f32 v164, v156
    v_mfma_f32_16x16x32_bf16 v[140:143], a[20:23], v[184:187], v[140:143]
    s_waitcnt lgkmcnt(0)
    v_exp_f32 v165, v157
    v_mfma_f32_16x16x32_bf16 v[136:139], a[8:11], v[188:191], v[136:139]
    v_exp_f32 v166, v158
    v_mfma_f32_16x16x32_bf16 v[140:143], a[24:27], v[188:191], v[140:143]
    v_exp_f32 v167, v159
    v_mfma_f32_16x16x32_bf16 v[136:139], a[12:15], v[192:195], v[136:139]
    s_add_u32 s71, s71, s71
    ds_write_b32 v6, v7
    v_cvt_pk_bf16_f32 v176, v160, v161
    v_mfma_f32_16x16x32_bf16 v[140:143], a[28:31], v[192:195], v[140:143]
    s_cselect_b32 s72, 1, 0
    v_cvt_pk_bf16_f32 v177, v162, v163
    v_cvt_pk_bf16_f32 v178, v164, v165
    v_mfma_f32_16x16x32_bf16 v[48:51], a[32:35], v[172:175], v[48:51]
    v_cvt_pk_bf16_f32 v179, v166, v167
    v_or3_b32 v250, v176, v177, v178
    v_mfma_f32_16x16x32_bf16 v[52:55], a[36:39], v[172:175], v[52:55]
    ds_read_b32 v5, v4
    v_bitop3_b32 v250, v250, v179, s63 bitop3:0xa8
    v_mfma_f32_16x16x32_bf16 v[56:59], a[40:43], v[172:175], v[56:59]
    v_cmp_ne_u32 vcc, s72, v250
    v_exp_f32 v160, v136
    v_mfma_f32_16x16x32_bf16 v[60:63], a[44:47], v[172:175], v[60:63]
    v_exp_f32 v161, v137
    v_mfma_f32_16x16x32_bf16 v[64:67], a[48:51], v[172:175], v[64:67]
    s_cbranch_vccnz L_stub14
L_ret14:
    v_exp_f32 v162, v138
    v_mfma_f32_16x16x32_bf16 v[68:71], a[52:55], v[172:175], v[68:71]
    v_exp_f32 v163, v139
    v_mfma_f32_16x16x32_bf16 v[72:75], a[56:59], v[172:175], v[72:75]
    v_exp_f32 v164, v140
    v_mfma_f32_16x16x32_bf16 v[76:79], a[60:63], v[172:175], v[76:79]
    v_exp_f32 v165, v141
    v_mfma_f32_16x16x32_bf16 v[116:119], v[252:255], v[172:175], v[116:119]
    v_exp_f32 v166, v142
    s_branch L_att
L_att_tail:
    v_mov_b32 v7, 33
    s_waitcnt lgkmcnt(0)
    ds_write_b32 v6, v7
    ds_read_b128 v[240:243], v4
    v_mfma_f32_16x16x32_bf16 v[48:51], a[32:35], v[172:175], v[48:51]
    v_exp_f32 v161, v153
    v_mfma_f32_16x16x32_bf16 v[52:55], a[36:39], v[172:175], v[52:55]
    v_exp_f32 v162, v154
    v_mfma_f32_16x16x32_bf16 v[56:59], a[40:43], v[172:175], v[56:59]
    v_exp_f32 v163, v155
    v_mfma_f32_16x16x32_bf16 v[60:63], a[44:47], v[172:175], v[60:63]
    v_exp_f32 v164, v156
    v_mfma_f32_16x16x32_bf16 v[64:67], a[48:51], v[172:175], v[64:67]
    v_exp_f32 v165, v157
    v_mfma_f32_16x16x32_bf16 v[68:71], a[52:55], v[172:175], v[68:71]
    v_exp_f32 v166, v158
    v_mfma_f32_16x16x32_bf16 v[72:75], a[56:59], v[172:175], v[72:75]
    v_exp_f32 v167, v159
    v_mfma_f32_16x16x32_bf16 v[76:79], a[60:63], v[172:175], v[76:79]
    v_cvt_pk_bf16_f32 v176, v160, v161
    v_cvt_pk_bf16_f32 v177, v162, v163
    v_mfma_f32_16x16x32_bf16 v[116:119], v[252:255], v[172:175], v[116:119]
    v_cvt_pk_bf16_f32 v178, v164, v165
    v_cvt_pk_bf16_f32 v179, v166, v167
    v_or3_b32 v250, v176, v177, v178
    v_bitop3_b32 v250, v250, v179, s63 bitop3:0xa8
    v_cmp_ne_u32 vcc, 0, v250
    s_mul_i32 s76, s53, 9
    s_mul_i32 s56, s3, 3
    s_add_u32 s76, s76, s56
    s_lshl_b32 s76, s76, 5
    s_add_u32 s55, s76, s52
    s_lshl_b32 s55, s55, 12
    s_cbranch_vccnz L_stub16
L_ret16:
    v_lshlrev_b32 v1, 4, v0
    s_waitcnt lgkmcnt(0)
    v_readfirstlane_b32 s100, v241
    v_readfirstlane_b32 s101, v242
    v_mfma_f32_16x16x32_bf16 v[80:83], a[32:35], v[176:179], v[80:83]
    v_rcp_f32 v2, v112
    v_rcp_f32 v3, v112
    v_mfma_f32_16x16x32_bf16 v[84:87], a[36:39], v[176:179], v[84:87]
    s_nop 0
    v_mul_f32 v16, v2, v16
    v_mfma_f32_16x16x32_bf16 v[88:91], a[40:43], v[176:179], v[88:91]
    v_mul_f32 v17, v2, v17
    v_mul_f32 v18, v2, v18
    v_mfma_f32_16x16x32_bf16 v[92:95], a[44:47], v[176:179], v[92:95]
    v_mul_f32 v19, v2, v19
    v_mul_f32 v20, v2, v20
    v_mfma_f32_16x16x32_bf16 v[96:99], a[48:51], v[176:179], v[96:99]
    v_mul_f32 v21, v2, v21
    v_mul_f32 v22, v2, v22
    v_mfma_f32_16x16x32_bf16 v[100:103], a[52:55], v[176:179], v[100:103]
    v_mul_f32 v23, v2, v23
    v_cvt_pk_bf16_f32 v180, v16, v17
    v_mfma_f32_16x16x32_bf16 v[104:107], a[56:59], v[176:179], v[104:107]
    v_cvt_pk_bf16_f32 v181, v18, v19
    v_cvt_pk_bf16_f32 v182, v20, v21
    v_mfma_f32_16x16x32_bf16 v[108:111], a[60:63], v[176:179], v[108:111]
    v_cvt_pk_bf16_f32 v183, v22, v23
    buffer_store_dwordx4 v[180:183], v1, s[44:47], s55 offen offset:0 sc1
    v_mfma_f32_16x16x32_bf16 v[120:123], v[252:255], v[176:179], v[120:123]
    v_mul_f32 v24, v2, v24
    v_mul_f32 v25, v2, v25
    v_pk_mul_f32 v[26:27], v[26:27], v[2:3]
    v_pk_mul_f32 v[28:29], v[28:29], v[2:3]
    v_pk_mul_f32 v[30:31], v[30:31], v[2:3]
    v_cvt_pk_bf16_f32 v184, v24, v25
    v_cvt_pk_bf16_f32 v185, v26, v27
    v_cvt_pk_bf16_f32 v186, v28, v29
    v_cvt_pk_bf16_f32 v187, v30, v31
    buffer_store_dwordx4 v[184:187], v1, s[44:47], s55 offen offset:1024 sc1
    v_pk_mul_f32 v[32:33], v[32:33], v[2:3]
    v_pk_mul_f32 v[34:35], v[34:35], v[2:3]
    v_pk_mul_f32 v[36:37], v[36:37], v[2:3]
    v_pk_mul_f32 v[38:39], v[38:39], v[2:3]
    v_cvt_pk_bf16_f32 v188, v32, v33
    v_cvt_pk_bf16_f32 v189, v34, v35
    v_cvt_pk_bf16_f32 v190, v36, v37
    v_cvt_pk_bf16_f32 v191, v38, v39
    buffer_store_dwordx4 v[188:191], v1, s[44:47], s55 offen offset:2048 sc1
    v_pk_mul_f32 v[40:41], v[40:41], v[2:3]
    v_pk_mul_f32 v[42:43], v[42:43], v[2:3]
    v_pk_mul_f32 v[44:45], v[44:45], v[2:3]
    v_pk_mul_f32 v[46:47], v[46:47], v[2:3]
    v_cvt_pk_bf16_f32 v192, v40, v41
    v_cvt_pk_bf16_f32 v193, v42, v43
    v_cvt_pk_bf16_f32 v194, v44, v45
    v_cvt_pk_bf16_f32 v195, v46, v47
    buffer_store_dwordx4 v[192:195], v1, s[44:47], s55 offen offset:3072 sc1
    s_add_u32 s55, s55, 131072
    v_rcp_f32 v2, v116
    v_rcp_f32 v3, v116
    s_nop 0
    v_pk_mul_f32 v[48:49], v[48:49], v[2:3]
    v_pk_mul_f32 v[50:51], v[50:51], v[2:3]
    v_pk_mul_f32 v[52:53], v[52:53], v[2:3]
    v_pk_mul_f32 v[54:55], v[54:55], v[2:3]
    v_cvt_pk_bf16_f32 v196, v48, v49
    v_cvt_pk_bf16_f32 v197, v50, v51
    v_cvt_pk_bf16_f32 v198, v52, v53
    v_cvt_pk_bf16_f32 v199, v54, v55
    buffer_store_dwordx4 v[196:199], v1, s[44:47], s55 offen offset:0 sc1
    v_pk_mul_f32 v[56:57], v[56:57], v[2:3]
    v_pk_mul_f32 v[58:59], v[58:59], v[2:3]
    v_pk_mul_f32 v[60:61], v[60:61], v[2:3]
    v_pk_mul_f32 v[62:63], v[62:63], v[2:3]
    v_cvt_pk_bf16_f32 v200, v56, v57
    v_cvt_pk_bf16_f32 v201, v58, v59
    v_cvt_pk_bf16_f32 v202, v60, v61
    v_cvt_pk_bf16_f32 v203, v62, v63
    buffer_store_dwordx4 v[200:203], v1, s[44:47], s55 offen offset:1024 sc1
    v_pk_mul_f32 v[64:65], v[64:65], v[2:3]
    v_pk_mul_f32 v[66:67], v[66:67], v[2:3]
    v_pk_mul_f32 v[68:69], v[68:69], v[2:3]
    v_pk_mul_f32 v[70:71], v[70:71], v[2:3]
    v_cvt_pk_bf16_f32 v204, v64, v65
    v_cvt_pk_bf16_f32 v205, v66, v67
    v_cvt_pk_bf16_f32 v206, v68, v69
    v_cvt_pk_bf16_f32 v207, v70, v71
    buffer_store_dwordx4 v[204:207], v1, s[44:47], s55 offen offset:2048 sc1
    v_pk_mul_f32 v[72:73], v[72:73], v[2:3]
    v_pk_mul_f32 v[74:75], v[74:75], v[2:3]
    v_pk_mul_f32 v[76:77], v[76:77], v[2:3]
    v_pk_mul_f32 v[78:79], v[78:79], v[2:3]
    v_cvt_pk_bf16_f32 v208, v72, v73
    v_cvt_pk_bf16_f32 v209, v74, v75
    v_cvt_pk_bf16_f32 v210, v76, v77
    v_cvt_pk_bf16_f32 v211, v78, v79
    buffer_store_dwordx4 v[208:211], v1, s[44:47], s55 offen offset:3072 sc1
    s_add_u32 s55, s55, 131072
    v_rcp_f32 v2, v120
    v_rcp_f32 v3, v120
    s_nop 0
    v_pk_mul_f32 v[80:81], v[80:81], v[2:3]
    v_pk_mul_f32 v[82:83], v[82:83], v[2:3]
    v_pk_mul_f32 v[84:85], v[84:85], v[2:3]
    v_pk_mul_f32 v[86:87], v[86:87], v[2:3]
    v_cvt_pk_bf16_f32 v212, v80, v81
    v_cvt_pk_bf16_f32 v213, v82, v83
    v_cvt_pk_bf16_f32 v214, v84, v85
    v_cvt_pk_bf16_f32 v215, v86, v87
    buffer_store_dwordx4 v[212:215], v1, s[44:47], s55 offen offset:0 sc1
    v_pk_mul_f32 v[88:89], v[88:89], v[2:3]
    v_pk_mul_f32 v[90:91], v[90:91], v[2:3]
    v_pk_mul_f32 v[92:93], v[92:93], v[2:3]
    v_pk_mul_f32 v[94:95], v[94:95], v[2:3]
    v_cvt_pk_bf16_f32 v216, v88, v89
    v_cvt_pk_bf16_f32 v217, v90, v91
    v_cvt_pk_bf16_f32 v218, v92, v93
    v_cvt_pk_bf16_f32 v219, v94, v95
    buffer_store_dwordx4 v[216:219], v1, s[44:47], s55 offen offset:1024 sc1
    v_pk_mul_f32 v[96:97], v[96:97], v[2:3]
    v_pk_mul_f32 v[98:99], v[98:99], v[2:3]
    v_pk_mul_f32 v[100:101], v[100:101], v[2:3]
    v_pk_mul_f32 v[102:103], v[102:103], v[2:3]
    v_cvt_pk_bf16_f32 v220, v96, v97
    v_cvt_pk_bf16_f32 v221, v98, v99
    v_cvt_pk_bf16_f32 v222, v100, v101
    v_cvt_pk_bf16_f32 v223, v102, v103
    buffer_store_dwordx4 v[220:223], v1, s[44:47], s55 offen offset:2048 sc1
    v_pk_mul_f32 v[104:105], v[104:105], v[2:3]
    v_pk_mul_f32 v[106:107], v[106:107], v[2:3]
    v_pk_mul_f32 v[108:109], v[108:109], v[2:3]
    v_pk_mul_f32 v[110:111], v[110:111], v[2:3]
    v_cvt_pk_bf16_f32 v224, v104, v105
    v_cvt_pk_bf16_f32 v225, v106, v107
    v_cvt_pk_bf16_f32 v226, v108, v109
    v_cvt_pk_bf16_f32 v227, v110, v111
    buffer_store_dwordx4 v[224:227], v1, s[44:47], s55 offen offset:3072 sc1
    s_add_u32 s55, s55, 131072
    v_mov_b32 v240, s100
    v_mov_b32 v241, s101
    v_mov_b32 v242, 0
    ds_read_b64_tr_b16 v[160:161], v10 offset:5120
    ds_read_b64_tr_b16 v[162:163], v10 offset:7680
    ds_read_b64_tr_b16 v[164:165], v10 offset:5152
    ds_read_b64_tr_b16 v[166:167], v10 offset:7712
    ds_read_b64_tr_b16 v[168:169], v10 offset:5184
    ds_read_b64_tr_b16 v[170:171], v10 offset:7744
    ds_read_b64_tr_b16 v[172:173], v10 offset:5216
    ds_read_b64_tr_b16 v[174:175], v10 offset:7776
    ds_read_b64_tr_b16 v[176:177], v10 offset:5248
    ds_read_b64_tr_b16 v[178:179], v10 offset:7808
    s_lshl3_add_u32 s76, s65, s76
    s_lshl_b32 s76, s76, 12
    v_add_u32 v12, 131072, v1
    v_add_u32 v13, 262144, v1
    v_mov_b32 v11, v1
    v_mov_b32 v7, 34
    v_and_b32 v14, 7, v0
    v_lshlrev_b32 v14, 9, v14
    s_lshl2_add_u32 s57, s54, s3
    s_lshl_b32 s57, s57, 7
    s_add_u32 s57, s57, 16777216
    s_waitcnt lgkmcnt(8)
    v_mfma_f32_16x16x32_bf16 v[16:19], v[160:163], v[180:183], 0
    v_mfma_f32_16x16x32_bf16 v[20:23], v[160:163], v[196:199], 0
    s_waitcnt lgkmcnt(6)
    v_mfma_f32_16x16x32_bf16 v[24:27], v[160:163], v[212:215], 0
    ds_read_b64_tr_b16 v[160:161], v10 offset:10240
    v_mfma_f32_16x16x32_bf16 v[28:31], v[164:167], v[180:183], 0
    ds_read_b64_tr_b16 v[162:163], v10 offset:12800
    v_mfma_f32_16x16x32_bf16 v[32:35], v[164:167], v[196:199], 0
    s_waitcnt lgkmcnt(6)
    v_mfma_f32_16x16x32_bf16 v[36:39], v[164:167], v[212:215], 0
    ds_read_b64_tr_b16 v[164:165], v10 offset:10272
    v_mfma_f32_16x16x32_bf16 v[40:43], v[168:171], v[180:183], 0
    ds_read_b64_tr_b16 v[166:167], v10 offset:12832
    v_mfma_f32_16x16x32_bf16 v[44:47], v[168:171], v[196:199], 0
    s_waitcnt lgkmcnt(6)
    v_mfma_f32_16x16x32_bf16 v[48:51], v[168:171], v[212:215], 0
    ds_read_b64_tr_b16 v[168:169], v10 offset:10304
    v_mfma_f32_16x16x32_bf16 v[52:55], v[172:175], v[180:183], 0
    ds_read_b64_tr_b16 v[170:171], v10 offset:12864
    v_mfma_f32_16x16x32_bf16 v[56:59], v[172:175], v[196:199], 0
    s_waitcnt lgkmcnt(6)
    v_mfma_f32_16x16x32_bf16 v[60:63], v[172:175], v[212:215], 0
    ds_read_b64_tr_b16 v[172:173], v10 offset:10336
    v_mfma_f32_16x16x32_bf16 v[64:67], v[176:179], v[180:183], 0
    ds_read_b64_tr_b16 v[174:175], v10 offset:12896
    v_mfma_f32_16x16x32_bf16 v[68:71], v[176:179], v[196:199], 0
    s_waitcnt lgkmcnt(6)
    ds_write_b32 v6, v7
    v_mfma_f32_16x16x32_bf16 v[72:75], v[176:179], v[212:215], 0
    ds_read_b64_tr_b16 v[176:177], v10 offset:10368
    ds_read_b64_tr_b16 v[178:179], v10 offset:12928
    v_mfma_f32_16x16x32_bf16 v[16:19], v[160:163], v[184:187], v[16:19]
    v_mfma_f32_16x16x32_bf16 v[20:23], v[160:163], v[200:203], v[20:23]
    s_waitcnt lgkmcnt(7)
    v_mfma_f32_16x16x32_bf16 v[24:27], v[160:163], v[216:219], v[24:27]
    ds_read_b64_tr_b16 v[160:161], v10 offset:15360
    v_mfma_f32_16x16x32_bf16 v[28:31], v[164:167], v[184:187], v[28:31]
    ds_read_b64_tr_b16 v[162:163], v10 offset:17920
    v_mfma_f32_16x16x32_bf16 v[32:35], v[164:167], v[200:203], v[32:35]
    s_waitcnt lgkmcnt(7)
    v_mfma_f32_16x16x32_bf16 v[36:39], v[164:167], v[216:219], v[36:39]
    ds_read_b64_tr_b16 v[164:165], v10 offset:15392
    v_mfma_f32_16x16x32_bf16 v[40:43], v[168:171], v[184:187], v[40:43]
    ds_read_b64_tr_b16 v[166:167], v10 offset:17952
    v_mfma_f32_16x16x32_bf16 v[44:47], v[168:171], v[200:203], v[44:47]
    s_waitcnt lgkmcnt(7)
    v_mfma_f32_16x16x32_bf16 v[48:51], v[168:171], v[216:219], v[48:51]
    ds_read_b64_tr_b16 v[168:169], v10 offset:15424
    v_mfma_f32_16x16x32_bf16 v[52:55], v[172:175], v[184:187], v[52:55]
    ds_read_b64_tr_b16 v[170:171], v10 offset:17984
    v_mfma_f32_16x16x32_bf16 v[56:59], v[172:175], v[200:203], v[56:59]
    s_waitcnt lgkmcnt(6)
    v_mfma_f32_16x16x32_bf16 v[60:63], v[172:175], v[216:219], v[60:63]
    ds_read_b64_tr_b16 v[172:173], v10 offset:15456
    v_mfma_f32_16x16x32_bf16 v[64:67], v[176:179], v[184:187], v[64:67]
    ds_read_b64_tr_b16 v[174:175], v10 offset:18016
    v_mfma_f32_16x16x32_bf16 v[68:71], v[176:179], v[200:203], v[68:71]
    s_waitcnt lgkmcnt(6)
    v_mfma_f32_16x16x32_bf16 v[72:75], v[176:179], v[216:219], v[72:75]
    ds_read_b64_tr_b16 v[176:177], v10 offset:15488
    ds_read_b64_tr_b16 v[178:179], v10 offset:18048
    v_mfma_f32_16x16x32_bf16 v[16:19], v[160:163], v[188:191], v[16:19]
    v_mfma_f32_16x16x32_bf16 v[20:23], v[160:163], v[204:207], v[20:23]
    s_waitcnt lgkmcnt(6)
    v_mfma_f32_16x16x32_bf16 v[24:27], v[160:163], v[220:223], v[24:27]
    ds_read_b64_tr_b16 v[160:161], v10 offset:20480
    v_mfma_f32_16x16x32_bf16 v[28:31], v[164:167], v[188:191], v[28:31]
    ds_read_b64_tr_b16 v[162:163], v10 offset:23040
    v_mfma_f32_16x16x32_bf16 v[32:35], v[164:167], v[204:207], v[32:35]
    s_waitcnt lgkmcnt(6)
    v_mfma_f32_16x16x32_bf16 v[36:39], v[164:167], v[220:223], v[36:39]
    ds_read_b64_tr_b16 v[164:165], v10 offset:20512
    v_mfma_f32_16x16x32_bf16 v[40:43], v[168:171], v[188:191], v[40:43]
    ds_read_b64_tr_b16 v[166:167], v10 offset:23072
    v_mfma_f32_16x16x32_bf16 v[44:47], v[168:171], v[204:207], v[44:47]
    s_waitcnt lgkmcnt(6)
    v_mfma_f32_16x16x32_bf16 v[48:51], v[168:171], v[220:223], v[48:51]
    ds_read_b64_tr_b16 v[168:169], v10 offset:20544
    v_mfma_f32_16x16x32_bf16 v[52:55], v[172:175], v[188:191], v[52:55]
    ds_read_b64_tr_b16 v[170:171], v10 offset:23104
    v_mfma_f32_16x16x32_bf16 v[56:59], v[172:175], v[204:207], v[56:59]
    s_waitcnt lgkmcnt(6)
    v_mfma_f32_16x16x32_bf16 v[60:63], v[172:175], v[220:223], v[60:63]
    ds_read_b64_tr_b16 v[172:173], v10 offset:20576
    v_mfma_f32_16x16x32_bf16 v[64:67], v[176:179], v[188:191], v[64:67]
    ds_read_b64_tr_b16 v[174:175], v10 offset:23136
    v_mfma_f32_16x16x32_bf16 v[68:71], v[176:179], v[204:207], v[68:71]
    s_waitcnt lgkmcnt(6)
    v_mfma_f32_16x16x32_bf16 v[72:75], v[176:179], v[220:223], v[72:75]
    ds_read_b64_tr_b16 v[176:177], v10 offset:20608
    ds_read_b64_tr_b16 v[178:179], v10 offset:23168
    v_mfma_f32_16x16x32_bf16 v[16:19], v[160:163], v[192:195], v[16:19]
    v_mfma_f32_16x16x32_bf16 v[20:23], v[160:163], v[208:211], v[20:23]
    s_waitcnt lgkmcnt(6)
    v_mfma_f32_16x16x32_bf16 v[24:27], v[160:163], v[224:227], v[24:27]
    v_mfma_f32_16x16x32_bf16 v[28:31], v[164:167], v[192:195], v[28:31]
    v_mfma_f32_16x16x32_bf16 v[32:35], v[164:167], v[208:211], v[32:35]
    s_waitcnt lgkmcnt(4)
    v_mfma_f32_16x16x32_bf16 v[36:39], v[164:167], v[224:227], v[36:39]
    v_mfma_f32_16x16x32_bf16 v[40:43], v[168:171], v[192:195], v[40:43]
    v_mfma_f32_16x16x32_bf16 v[44:47], v[168:171], v[208:211], v[44:47]
    s_waitcnt lgkmcnt(2)
    v_mfma_f32_16x16x32_bf16 v[48:51], v[168:171], v[224:227], v[48:51]
    v_mfma_f32_16x16x32_bf16 v[52:55], v[172:175], v[192:195], v[52:55]
    v_mfma_f32_16x16x32_bf16 v[56:59], v[172:175], v[208:211], v[56:59]
    s_waitcnt lgkmcnt(0)
    v_mfma_f32_16x16x32_bf16 v[60:63], v[172:175], v[224:227], v[60:63]
    v_mfma_f32_16x16x32_bf16 v[64:67], v[176:179], v[192:195], v[64:67]
    v_mfma_f32_16x16x32_bf16 v[68:71], v[176:179], v[208:211], v[68:71]
    v_mfma_f32_16x16x32_bf16 v[72:75], v[176:179], v[224:227], v[72:75]
    s_waitcnt vmcnt(0)
    s_mov_b64 exec, 1
    buffer_store_dwordx2 v[240:241], v242, s[44:47], s57 offen sc1
    s_mov_b64 exec, -1
    ds_read_b64_tr_b16 v[160:161], v10 offset:25600
    ds_read_b64_tr_b16 v[162:163], v10 offset:28160
    ds_read_b64_tr_b16 v[164:165], v10 offset:25632
    ds_read_b64_tr_b16 v[166:167], v10 offset:28192
    ds_read_b64_tr_b16 v[168:169], v10 offset:25728
    ds_read_b64_tr_b16 v[170:171], v10 offset:28288
    s_lshl_b32 s56, s66, 9
    s_sub_u32 s57, s57, s56
    s_mov_b32 s67, 0
L_polla:
    buffer_load_dwordx2 v[2:3], v14, s[44:47], s57 offen sc1
    s_add_u32 s67, s67, 1
    s_waitcnt vmcnt(0)
    v_cmp_ne_u64 vcc, s[100:101], v[2:3]
    s_cmp_ge_u32 s67, 0x40000
    s_cbranch_scc1 L_polla_end
    s_cbranch_vccz L_polla_end
    s_sleep 1
    s_branch L_polla
L_polla_end:
    s_bfe_u32 s56, s19, 0x30004
    s_lshl_b32 s56, s56, 12
    s_add_u32 s73, s76, s56
    buffer_load_dwordx4 a[0:3], v11, s[44:47], s73 offen offset:0 sc1
    buffer_load_dwordx4 a[4:7], v12, s[44:47], s73 offen offset:0 sc1
    buffer_load_dwordx4 a[8:11], v13, s[44:47], s73 offen offset:0 sc1
    buffer_load_dwordx4 a[12:15], v11, s[44:47], s73 offen offset:1024 sc1
    buffer_load_dwordx4 a[16:19], v12, s[44:47], s73 offen offset:1024 sc1
    buffer_load_dwordx4 a[20:23], v13, s[44:47], s73 offen offset:1024 sc1
    buffer_load_dwordx4 a[24:27], v11, s[44:47], s73 offen offset:2048 sc1
    buffer_load_dwordx4 a[28:31], v12, s[44:47], s73 offen offset:2048 sc1
    buffer_load_dwordx4 a[32:35], v13, s[44:47], s73 offen offset:2048 sc1
    buffer_load_dwordx4 a[36:39], v11, s[44:47], s73 offen offset:3072 sc1
    buffer_load_dwordx4 a[40:43], v12, s[44:47], s73 offen offset:3072 sc1
    buffer_load_dwordx4 a[44:47], v13, s[44:47], s73 offen offset:3072 sc1
    s_bfe_u32 s56, s19, 0x30008
    s_lshl_b32 s56, s56, 12
    s_add_u32 s73, s76, s56
    buffer_load_dwordx4 a[48:51], v11, s[44:47], s73 offen offset:0 sc1
    buffer_load_dwordx4 a[52:55], v12, s[44:47], s73 offen offset:0 sc1
    buffer_load_dwordx4 a[56:59], v13, s[44:47], s73 offen offset:0 sc1
    s_lshl3_add_u32 s77, s53, s66
    s_mul_i32 s77, s77, 196608
    s_lshl_b32 s55, s3, 12
    s_add_u32 s77, s77, s55
    s_add_u32 s77, s77, 20971520
    s_mul_i32 s55, s65, 12288
    s_add_u32 s72, s77, s55
    s_mul_i32 s55, s65, 49152
    s_add_u32 s77, s77, s55
    v_and_b32 v15, 15, v0
    v_mul_u32_u24 v15, 1280, v15
    v_lshrrev_b32 v7, 4, v0
    v_lshl_add_u32 v15, v7, 3, v15
    v_mov_b32 v183, s100
    v_mov_b32 v187, s100
    v_mov_b32 v191, s100
    v_mov_b32 v195, s100
    v_mov_b32 v199, s100
    v_mov_b32 v203, s100
    v_mov_b32 v207, s100
    v_mov_b32 v211, s100
    v_mov_b32 v215, s100
    v_mov_b32 v206, 0
    v_mov_b32 v210, 0
    v_mov_b32 v214, 0
    s_waitcnt lgkmcnt(0)
    s_waitcnt vmcnt(12)
    v_mfma_f32_16x16x32_bf16 v[16:19], v[160:163], a[0:3], v[16:19]
    buffer_load_dwordx4 a[60:63], v11, s[44:47], s73 offen offset:1024 sc1
    v_mfma_f32_16x16x32_bf16 v[20:23], v[160:163], a[4:7], v[20:23]
    v_mfma_f32_16x16x32_bf16 v[24:27], v[160:163], a[8:11], v[24:27]
    ds_read_b64_tr_b16 v[160:161], v10 offset:30720
    v_mfma_f32_16x16x32_bf16 v[28:31], v[164:167], a[0:3], v[28:31]
    ds_read_b64_tr_b16 v[162:163], v10 offset:33280
    v_mfma_f32_16x16x32_bf16 v[32:35], v[164:167], a[4:7], v[32:35]
    buffer_load_dwordx4 a[64:67], v12, s[44:47], s73 offen offset:1024 sc1
    v_mfma_f32_16x16x32_bf16 v[36:39], v[164:167], a[8:11], v[36:39]
    ds_read_b64_tr_b16 v[164:165], v10 offset:30752
    v_mfma_f32_16x16x32_bf16 v[64:67], v[168:171], a[0:3], v[64:67]
    ds_read_b64_tr_b16 v[166:167], v10 offset:33312
    v_mfma_f32_16x16x32_bf16 v[68:71], v[168:171], a[4:7], v[68:71]
    s_waitcnt lgkmcnt(2)
    buffer_load_dwordx4 a[68:71], v13, s[44:47], s73 offen offset:1024 sc1
    v_mfma_f32_16x16x32_bf16 v[72:75], v[168:171], a[8:11], v[72:75]
    ds_read_b64_tr_b16 v[168:169], v10 offset:30848
    ds_read_b64_tr_b16 v[170:171], v10 offset:33408
    s_waitcnt vmcnt(12)
    v_mfma_f32_16x16x32_bf16 v[16:19], v[160:163], a[12:15], v[16:19]
    buffer_load_dwordx4 a[72:75], v11, s[44:47], s73 offen offset:2048 sc1
    v_mfma_f32_16x16x32_bf16 v[20:23], v[160:163], a[16:19], v[20:23]
    s_waitcnt lgkmcnt(2)
    v_mfma_f32_16x16x32_bf16 v[24:27], v[160:163], a[20:23], v[24:27]
    ds_read_b64_tr_b16 v[160:161], v9 offset:0
    v_mfma_f32_16x16x32_bf16 v[28:31], v[164:167], a[12:15], v[28:31]
    ds_read_b64_tr_b16 v[162:163], v9 offset:2560
    v_mfma_f32_16x16x32_bf16 v[32:35], v[164:167], a[16:19], v[32:35]
    s_waitcnt lgkmcnt(2)
    buffer_load_dwordx4 a[76:79], v12, s[44:47], s73 offen offset:2048 sc1
    v_mfma_f32_16x16x32_bf16 v[36:39], v[164:167], a[20:23], v[36:39]
    ds_read_b64_tr_b16 v[164:165], v9 offset:32
    v_mfma_f32_16x16x32_bf16 v[64:67], v[168:171], a[12:15], v[64:67]
    ds_read_b64_tr_b16 v[166:167], v9 offset:2592
    v_mfma_f32_16x16x32_bf16 v[68:71], v[168:171], a[16:19], v[68:71]
    s_waitcnt lgkmcnt(2)
    buffer_load_dwordx4 a[80:83], v13, s[44:47], s73 offen offset:2048 sc1
    v_mfma_f32_16x16x32_bf16 v[72:75], v[168:171], a[20:23], v[72:75]
    ds_read_b64_tr_b16 v[168:169], v9 offset:128
    ds_read_b64_tr_b16 v[170:171], v9 offset:2688
    s_waitcnt vmcnt(12)
    v_mfma_f32_16x16x32_bf16 v[16:19], v[160:163], a[24:27], v[16:19]
    buffer_load_dwordx4 a[84:87], v11, s[44:47], s73 offen offset:3072 sc1
    v_mfma_f32_16x16x32_bf16 v[20:23], v[160:163], a[28:31], v[20:23]
    s_waitcnt lgkmcnt(2)
    v_mfma_f32_16x16x32_bf16 v[24:27], v[160:163], a[32:35], v[24:27]
    ds_read_b64_tr_b16 v[160:161], v9 offset:5120
    v_mfma_f32_16x16x32_bf16 v[28:31], v[164:167], a[24:27], v[28:31]
    ds_read_b64_tr_b16 v[162:163], v9 offset:7680
    v_mfma_f32_16x16x32_bf16 v[32:35], v[164:167], a[28:31], v[32:35]
    s_waitcnt lgkmcnt(2)
    buffer_load_dwordx4 a[88:91], v12, s[44:47], s73 offen offset:3072 sc1
    v_mfma_f32_16x16x32_bf16 v[36:39], v[164:167], a[32:35], v[36:39]
    ds_read_b64_tr_b16 v[164:165], v9 offset:5152
    v_mfma_f32_16x16x32_bf16 v[64:67], v[168:171], a[24:27], v[64:67]
    ds_read_b64_tr_b16 v[166:167], v9 offset:7712
    v_mfma_f32_16x16x32_bf16 v[68:71], v[168:171], a[28:31], v[68:71]
    s_waitcnt lgkmcnt(2)
    buffer_load_dwordx4 a[92:95], v13, s[44:47], s73 offen offset:3072 sc1
    v_mfma_f32_16x16x32_bf16 v[72:75], v[168:171], a[32:35], v[72:75]
    ds_read_b64_tr_b16 v[168:169], v9 offset:5248
    ds_read_b64_tr_b16 v[170:171], v9 offset:7808
    s_waitcnt vmcnt(12)
    v_mfma_f32_16x16x32_bf16 v[16:19], v[160:163], a[36:39], v[16:19]
    s_bfe_u32 s56, s19, 0x3000c
    s_lshl_b32 s56, s56, 12
    s_add_u32 s73, s76, s56
    buffer_load_dwordx4 a[96:99], v11, s[44:47], s73 offen offset:0 sc1
    v_mfma_f32_16x16x32_bf16 v[20:23], v[160:163], a[40:43], v[20:23]
    s_waitcnt lgkmcnt(2)
    v_mfma_f32_16x16x32_bf16 v[24:27], v[160:163], a[44:47], v[24:27]
    ds_read_b64_tr_b16 v[160:161], v9 offset:10240
    v_mfma_f32_16x16x32_bf16 v[28:31], v[164:167], a[36:39], v[28:31]
    ds_read_b64_tr_b16 v[162:163], v9 offset:12800
    v_mfma_f32_16x16x32_bf16 v[32:35], v[164:167], a[40:43], v[32:35]
    s_waitcnt lgkmcnt(2)
    buffer_load_dwordx4 a[100:103], v12, s[44:47], s73 offen offset:0 sc1
    v_mfma_f32_16x16x32_bf16 v[36:39], v[164:167], a[44:47], v[36:39]
    ds_read_b64_tr_b16 v[164:165], v9 offset:10272
    v_mfma_f32_16x16x32_bf16 v[64:67], v[168:171], a[36:39], v[64:67]
    ds_read_b64_tr_b16 v[166:167], v9 offset:12832
    v_mfma_f32_16x16x32_bf16 v[68:71], v[168:171], a[40:43], v[68:71]
    s_waitcnt lgkmcnt(2)
    buffer_load_dwordx4 a[104:107], v13, s[44:47], s73 offen offset:0 sc1
    v_mfma_f32_16x16x32_bf16 v[72:75], v[168:171], a[44:47], v[72:75]
    ds_read_b64_tr_b16 v[168:169], v9 offset:10368
    ds_read_b64_tr_b16 v[170:171], v9 offset:12928
    s_waitcnt vmcnt(12)
    v_mfma_f32_16x16x32_bf16 v[16:19], v[160:163], a[48:51], v[16:19]
    buffer_load_dwordx4 a[108:111], v11, s[44:47], s73 offen offset:1024 sc1
    v_mfma_f32_16x16x32_bf16 v[20:23], v[160:163], a[52:55], v[20:23]
    s_waitcnt lgkmcnt(2)
    v_mfma_f32_16x16x32_bf16 v[24:27], v[160:163], a[56:59], v[24:27]
    ds_read_b64_tr_b16 v[160:161], v9 offset:15360
    v_mfma_f32_16x16x32_bf16 v[28:31], v[164:167], a[48:51], v[28:31]
    ds_read_b64_tr_b16 v[162:163], v9 offset:17920
    v_mfma_f32_16x16x32_bf16 v[32:35], v[164:167], a[52:55], v[32:35]
    s_waitcnt lgkmcnt(2)
    buffer_load_dwordx4 a[112:115], v12, s[44:47], s73 offen offset:1024 sc1
    v_mfma_f32_16x16x32_bf16 v[36:39], v[164:167], a[56:59], v[36:39]
    ds_read_b64_tr_b16 v[164:165], v9 offset:15392
    v_mfma_f32_16x16x32_bf16 v[64:67], v[168:171], a[48:51], v[64:67]
    ds_read_b64_tr_b16 v[166:167], v9 offset:17952
    v_mfma_f32_16x16x32_bf16 v[68:71], v[168:171], a[52:55], v[68:71]
    s_waitcnt lgkmcnt(2)
    buffer_load_dwordx4 a[116:119], v13, s[44:47], s73 offen offset:1024 sc1
    v_mfma_f32_16x16x32_bf16 v[72:75], v[168:171], a[56:59], v[72:75]
    ds_read_b64_tr_b16 v[168:169], v9 offset:15488
    ds_read_b64_tr_b16 v[170:171], v9 offset:18048
    s_waitcnt vmcnt(12)
    v_mfma_f32_16x16x32_bf16 v[16:19], v[160:163], a[60:63], v[16:19]
    buffer_load_dwordx4 a[120:123], v11, s[44:47], s73 offen offset:2048 sc1
    v_mfma_f32_16x16x32_bf16 v[20:23], v[160:163], a[64:67], v[20:23]
    s_waitcnt lgkmcnt(2)
    v_mfma_f32_16x16x32_bf16 v[24:27], v[160:163], a[68:71], v[24:27]
    ds_read_b64_tr_b16 v[160:161], v9 offset:20480
    v_mfma_f32_16x16x32_bf16 v[28:31], v[164:167], a[60:63], v[28:31]
    ds_read_b64_tr_b16 v[162:163], v9 offset:23040
    v_mfma_f32_16x16x32_bf16 v[32:35], v[164:167], a[64:67], v[32:35]
    s_waitcnt lgkmcnt(2)
    buffer_load_dwordx4 a[124:127], v12, s[44:47], s73 offen offset:2048 sc1
    v_mfma_f32_16x16x32_bf16 v[36:39], v[164:167], a[68:71], v[36:39]
    ds_read_b64_tr_b16 v[164:165], v9 offset:20512
    v_mfma_f32_16x16x32_bf16 v[64:67], v[168:171], a[60:63], v[64:67]
    ds_read_b64_tr_b16 v[166:167], v9 offset:23072
    v_mfma_f32_16x16x32_bf16 v[68:71], v[168:171], a[64:67], v[68:71]
    s_waitcnt lgkmcnt(2)
    buffer_load_dwordx4 a[128:131], v13, s[44:47], s73 offen offset:2048 sc1
    v_mfma_f32_16x16x32_bf16 v[72:75], v[168:171], a[68:71], v[72:75]
    ds_read_b64_tr_b16 v[168:169], v9 offset:20608
    ds_read_b64_tr_b16 v[170:171], v9 offset:23168
    s_waitcnt vmcnt(12)
    v_mfma_f32_16x16x32_bf16 v[16:19], v[160:163], a[72:75], v[16:19]
    buffer_load_dwordx4 a[132:135], v11, s[44:47], s73 offen offset:3072 sc1
    v_mfma_f32_16x16x32_bf16 v[20:23], v[160:163], a[76:79], v[20:23]
    s_waitcnt lgkmcnt(2)
    v_mfma_f32_16x16x32_bf16 v[24:27], v[160:163], a[80:83], v[24:27]
    ds_read_b64_tr_b16 v[160:161], v9 offset:25600
    v_mfma_f32_16x16x32_bf16 v[28:31], v[164:167], a[72:75], v[28:31]
    ds_read_b64_tr_b16 v[162:163], v9 offset:28160
    v_mfma_f32_16x16x32_bf16 v[32:35], v[164:167], a[76:79], v[32:35]
    s_waitcnt lgkmcnt(2)
    buffer_load_dwordx4 a[136:139], v12, s[44:47], s73 offen offset:3072 sc1
    v_mfma_f32_16x16x32_bf16 v[36:39], v[164:167], a[80:83], v[36:39]
    ds_read_b64_tr_b16 v[164:165], v9 offset:25632
    v_mfma_f32_16x16x32_bf16 v[64:67], v[168:171], a[72:75], v[64:67]
    ds_read_b64_tr_b16 v[166:167], v9 offset:28192
    v_mfma_f32_16x16x32_bf16 v[68:71], v[168:171], a[76:79], v[68:71]
    s_waitcnt lgkmcnt(2)
    buffer_load_dwordx4 a[140:143], v13, s[44:47], s73 offen offset:3072 sc1
    v_mfma_f32_16x16x32_bf16 v[72:75], v[168:171], a[80:83], v[72:75]
    ds_read_b64_tr_b16 v[168:169], v9 offset:25728
    ds_read_b64_tr_b16 v[170:171], v9 offset:28288
    s_waitcnt vmcnt(12)
    v_mfma_f32_16x16x32_bf16 v[16:19], v[160:163], a[84:87], v[16:19]
    s_bfe_u32 s56, s19, 0x30010
    s_lshl_b32 s56, s56, 12
    s_add_u32 s73, s76, s56
    buffer_load_dwordx4 a[144:147], v11, s[44:47], s73 offen offset:0 sc1
    v_mfma_f32_16x16x32_bf16 v[20:23], v[160:163], a[88:91], v[20:23]
    s_waitcnt lgkmcnt(2)
    v_mfma_f32_16x16x32_bf16 v[24:27], v[160:163], a[92:95], v[24:27]
    ds_read_b64_tr_b16 v[160:161], v9 offset:30720
    v_mfma_f32_16x16x32_bf16 v[28:31], v[164:167], a[84:87], v[28:31]
    ds_read_b64_tr_b16 v[162:163], v9 offset:33280
    v_mfma_f32_16x16x32_bf16 v[32:35], v[164:167], a[88:91], v[32:35]
    s_waitcnt lgkmcnt(2)
    buffer_load_dwordx4 a[148:151], v12, s[44:47], s73 offen offset:0 sc1
    v_mfma_f32_16x16x32_bf16 v[36:39], v[164:167], a[92:95], v[36:39]
    ds_read_b64_tr_b16 v[164:165], v9 offset:30752
    v_mfma_f32_16x16x32_bf16 v[64:67], v[168:171], a[84:87], v[64:67]
    ds_read_b64_tr_b16 v[166:167], v9 offset:33312
    v_mfma_f32_16x16x32_bf16 v[68:71], v[168:171], a[88:91], v[68:71]
    s_waitcnt lgkmcnt(2)
    buffer_load_dwordx4 a[152:155], v13, s[44:47], s73 offen offset:0 sc1
    v_mfma_f32_16x16x32_bf16 v[72:75], v[168:171], a[92:95], v[72:75]
    ds_read_b64_tr_b16 v[168:169], v9 offset:30848
    ds_read_b64_tr_b16 v[170:171], v9 offset:33408
    s_waitcnt vmcnt(12)
    v_mfma_f32_16x16x32_bf16 v[16:19], v[160:163], a[96:99], v[16:19]
    buffer_load_dwordx4 a[156:159], v11, s[44:47], s73 offen offset:1024 sc1
    v_mfma_f32_16x16x32_bf16 v[20:23], v[160:163], a[100:103], v[20:23]
    s_waitcnt lgkmcnt(2)
    v_mfma_f32_16x16x32_bf16 v[24:27], v[160:163], a[104:107], v[24:27]
    ds_read_b64_tr_b16 v[160:161], v9 offset:35840
    v_mfma_f32_16x16x32_bf16 v[28:31], v[164:167], a[96:99], v[28:31]
    ds_read_b64_tr_b16 v[162:163], v9 offset:38400
    v_mfma_f32_16x16x32_bf16 v[32:35], v[164:167], a[100:103], v[32:35]
    s_waitcnt lgkmcnt(2)
    buffer_load_dwordx4 a[160:163], v12, s[44:47], s73 offen offset:1024 sc1
    v_mfma_f32_16x16x32_bf16 v[36:39], v[164:167], a[104:107], v[36:39]
    ds_read_b64_tr_b16 v[164:165], v9 offset:35872
    v_mfma_f32_16x16x32_bf16 v[64:67], v[168:171], a[96:99], v[64:67]
    ds_read_b64_tr_b16 v[166:167], v9 offset:38432
    v_mfma_f32_16x16x32_bf16 v[68:71], v[168:171], a[100:103], v[68:71]
    s_waitcnt lgkmcnt(2)
    buffer_load_dwordx4 a[164:167], v13, s[44:47], s73 offen offset:1024 sc1
    v_mfma_f32_16x16x32_bf16 v[72:75], v[168:171], a[104:107], v[72:75]
    ds_read_b64_tr_b16 v[168:169], v9 offset:35968
    ds_read_b64_tr_b16 v[170:171], v9 offset:38528
    s_waitcnt vmcnt(12)
    v_mfma_f32_16x16x32_bf16 v[16:19], v[160:163], a[108:111], v[16:19]
    buffer_load_dwordx4 a[168:171], v11, s[44:47], s73 offen offset:2048 sc1
    v_mfma_f32_16x16x32_bf16 v[20:23], v[160:163], a[112:115], v[20:23]
    s_waitcnt lgkmcnt(2)
    v_mfma_f32_16x16x32_bf16 v[24:27], v[160:163], a[116:119], v[24:27]
    ds_read_b64_tr_b16 v[160:161], v9 offset:40960
    v_mfma_f32_16x16x32_bf16 v[28:31], v[164:167], a[108:111], v[28:31]
    ds_read_b64_tr_b16 v[162:163], v9 offset:43520
    v_mfma_f32_16x16x32_bf16 v[32:35], v[164:167], a[112:115], v[32:35]
    s_waitcnt lgkmcnt(2)
    buffer_load_dwordx4 a[172:175], v12, s[44:47], s73 offen offset:2048 sc1
    v_mfma_f32_16x16x32_bf16 v[36:39], v[164:167], a[116:119], v[36:39]
    ds_read_b64_tr_b16 v[164:165], v9 offset:40992
    v_mfma_f32_16x16x32_bf16 v[64:67], v[168:171], a[108:111], v[64:67]
    ds_read_b64_tr_b16 v[166:167], v9 offset:43552
    v_mfma_f32_16x16x32_bf16 v[68:71], v[168:171], a[112:115], v[68:71]
    s_waitcnt lgkmcnt(2)
    buffer_load_dwordx4 a[176:179], v13, s[44:47], s73 offen offset:2048 sc1
    v_mfma_f32_16x16x32_bf16 v[72:75], v[168:171], a[116:119], v[72:75]
    ds_read_b64_tr_b16 v[168:169], v9 offset:41088
    ds_read_b64_tr_b16 v[170:171], v9 offset:43648
    s_waitcnt vmcnt(12)
    v_mfma_f32_16x16x32_bf16 v[16:19], v[160:163], a[120:123], v[16:19]
    buffer_load_dwordx4 a[180:183], v11, s[44:47], s73 offen offset:3072 sc1
    v_mfma_f32_16x16x32_bf16 v[20:23], v[160:163], a[124:127], v[20:23]
    s_waitcnt lgkmcnt(2)
    v_mfma_f32_16x16x32_bf16 v[24:27], v[160:163], a[128:131], v[24:27]
    ds_read_b64_tr_b16 v[160:161], v9 offset:46080
    v_mfma_f32_16x16x32_bf16 v[28:31], v[164:167], a[120:123], v[28:31]
    ds_read_b64_tr_b16 v[162:163], v9 offset:48640
    v_mfma_f32_16x16x32_bf16 v[32:35], v[164:167], a[124:127], v[32:35]
    s_waitcnt lgkmcnt(2)
    buffer_load_dwordx4 a[184:187], v12, s[44:47], s73 offen offset:3072 sc1
    v_mfma_f32_16x16x32_bf16 v[36:39], v[164:167], a[128:131], v[36:39]
    ds_read_b64_tr_b16 v[164:165], v9 offset:46112
    v_mfma_f32_16x16x32_bf16 v[64:67], v[168:171], a[120:123], v[64:67]
    ds_read_b64_tr_b16 v[166:167], v9 offset:48672
    v_mfma_f32_16x16x32_bf16 v[68:71], v[168:171], a[124:127], v[68:71]
    s_waitcnt lgkmcnt(2)
    buffer_load_dwordx4 a[188:191], v13, s[44:47], s73 offen offset:3072 sc1
    v_mfma_f32_16x16x32_bf16 v[72:75], v[168:171], a[128:131], v[72:75]
    ds_read_b64_tr_b16 v[168:169], v9 offset:46208
    ds_read_b64_tr_b16 v[170:171], v9 offset:48768
    s_waitcnt vmcnt(12)
    v_mfma_f32_16x16x32_bf16 v[16:19], v[160:163], a[132:135], v[16:19]
    s_mov_b32 s62, 35
    ds_read_b32 v5, v4
    s_bfe_u32 s56, s19, 0x30014
    s_lshl_b32 s56, s56, 12
    s_add_u32 s73, s76, s56
    buffer_load_dwordx4 a[192:195], v11, s[44:47], s73 offen offset:0 sc1
    v_mfma_f32_16x16x32_bf16 v[20:23], v[160:163], a[136:139], v[20:23]
    s_waitcnt lgkmcnt(3)
    v_mfma_f32_16x16x32_bf16 v[24:27], v[160:163], a[140:143], v[24:27]
    ds_read_b64_tr_b16 v[160:161], v9 offset:51200
    v_mfma_f32_16x16x32_bf16 v[28:31], v[164:167], a[132:135], v[28:31]
    ds_read_b64_tr_b16 v[162:163], v9 offset:53760
    v_mfma_f32_16x16x32_bf16 v[32:35], v[164:167], a[136:139], v[32:35]
    s_waitcnt lgkmcnt(3)
    s_waitcnt lgkmcnt(2)
    v_cmp_gt_u32 vcc, s62, v5
    buffer_load_dwordx4 a[196:199], v12, s[44:47], s73 offen offset:0 sc1
    v_mfma_f32_16x16x32_bf16 v[36:39], v[164:167], a[140:143], v[36:39]
    ds_read_b64_tr_b16 v[164:165], v9 offset:51232
    v_mfma_f32_16x16x32_bf16 v[64:67], v[168:171], a[132:135], v[64:67]
    ds_read_b64_tr_b16 v[166:167], v9 offset:53792
    v_mfma_f32_16x16x32_bf16 v[68:71], v[168:171], a[136:139], v[68:71]
    s_cbranch_vccnz L_stub17
L_ret17:
    s_waitcnt lgkmcnt(2)
    buffer_load_dwordx4 a[200:203], v13, s[44:47], s73 offen offset:0 sc1
    v_mfma_f32_16x16x32_bf16 v[72:75], v[168:171], a[140:143], v[72:75]
    ds_read_b64_tr_b16 v[168:169], v9 offset:51328
    ds_read_b64_tr_b16 v[170:171], v9 offset:53888
    s_waitcnt vmcnt(12)
    v_mfma_f32_16x16x32_bf16 v[16:19], v[160:163], a[144:147], v[16:19]
    buffer_load_dwordx4 a[204:207], v11, s[44:47], s73 offen offset:1024 sc1
    v_mfma_f32_16x16x32_bf16 v[20:23], v[160:163], a[148:151], v[20:23]
    s_waitcnt lgkmcnt(2)
    v_mfma_f32_16x16x32_bf16 v[24:27], v[160:163], a[152:155], v[24:27]
    ds_read_b64_tr_b16 v[160:161], v9 offset:56320
    v_mfma_f32_16x16x32_bf16 v[28:31], v[164:167], a[144:147], v[28:31]
    ds_read_b64_tr_b16 v[162:163], v9 offset:58880
    v_mfma_f32_16x16x32_bf16 v[32:35], v[164:167], a[148:151], v[32:35]
    s_waitcnt lgkmcnt(2)
    buffer_load_dwordx4 a[208:211], v12, s[44:47], s73 offen offset:1024 sc1
    v_mfma_f32_16x16x32_bf16 v[36:39], v[164:167], a[152:155], v[36:39]
    ds_read_b64_tr_b16 v[164:165], v9 offset:56352
    v_mfma_f32_16x16x32_bf16 v[64:67], v[168:171], a[144:147], v[64:67]
    ds_read_b64_tr_b16 v[166:167], v9 offset:58912
    v_mfma_f32_16x16x32_bf16 v[68:71], v[168:171], a[148:151], v[68:71]
    s_waitcnt lgkmcnt(2)
    buffer_load_dwordx4 a[212:215], v13, s[44:47], s73 offen offset:1024 sc1
    v_mfma_f32_16x16x32_bf16 v[72:75], v[168:171], a[152:155], v[72:75]
    ds_read_b64_tr_b16 v[168:169], v9 offset:56448
    ds_read_b64_tr_b16 v[170:171], v9 offset:59008
    s_waitcnt vmcnt(12)
    v_mfma_f32_16x16x32_bf16 v[16:19], v[160:163], a[156:159], v[16:19]
    buffer_load_dwordx4 a[216:219], v11, s[44:47], s73 offen offset:2048 sc1
    v_mfma_f32_16x16x32_bf16 v[20:23], v[160:163], a[160:163], v[20:23]
    s_waitcnt lgkmcnt(2)
    v_mfma_f32_16x16x32_bf16 v[24:27], v[160:163], a[164:167], v[24:27]
    ds_read_b64_tr_b16 v[160:161], v10 offset:0
    v_mfma_f32_16x16x32_bf16 v[28:31], v[164:167], a[156:159], v[28:31]
    ds_read_b64_tr_b16 v[162:163], v10 offset:2560
    v_mfma_f32_16x16x32_bf16 v[32:35], v[164:167], a[160:163], v[32:35]
    s_waitcnt lgkmcnt(2)
    buffer_load_dwordx4 a[220:223], v12, s[44:47], s73 offen offset:2048 sc1
    v_mfma_f32_16x16x32_bf16 v[36:39], v[164:167], a[164:167], v[36:39]
    ds_read_b64_tr_b16 v[164:165], v10 offset:32
    v_mfma_f32_16x16x32_bf16 v[64:67], v[168:171], a[156:159], v[64:67]
    ds_read_b64_tr_b16 v[166:167], v10 offset:2592
    v_mfma_f32_16x16x32_bf16 v[68:71], v[168:171], a[160:163], v[68:71]
    s_waitcnt lgkmcnt(2)
    buffer_load_dwordx4 a[224:227], v13, s[44:47], s73 offen offset:2048 sc1
    v_mfma_f32_16x16x32_bf16 v[72:75], v[168:171], a[164:167], v[72:75]
    ds_read_b64_tr_b16 v[168:169], v10 offset:128
    ds_read_b64_tr_b16 v[170:171], v10 offset:2688
    s_waitcnt vmcnt(12)
    v_mfma_f32_16x16x32_bf16 v[16:19], v[160:163], a[168:171], v[16:19]
    buffer_load_dwordx4 a[228:231], v11, s[44:47], s73 offen offset:3072 sc1
    v_mfma_f32_16x16x32_bf16 v[20:23], v[160:163], a[172:175], v[20:23]
    s_waitcnt lgkmcnt(2)
    v_mfma_f32_16x16x32_bf16 v[24:27], v[160:163], a[176:179], v[24:27]
    ds_read_b64_tr_b16 v[160:161], v8 offset:0
    v_mfma_f32_16x16x32_bf16 v[28:31], v[164:167], a[168:171], v[28:31]
    ds_read_b64_tr_b16 v[162:163], v8 offset:2560
    v_mfma_f32_16x16x32_bf16 v[32:35], v[164:167], a[172:175], v[32:35]
    s_waitcnt lgkmcnt(2)
    buffer_load_dwordx4 a[232:235], v12, s[44:47], s73 offen offset:3072 sc1
    v_mfma_f32_16x16x32_bf16 v[36:39], v[164:167], a[176:179], v[36:39]
    ds_read_b64_tr_b16 v[164:165], v8 offset:32
    v_mfma_f32_16x16x32_bf16 v[64:67], v[168:171], a[168:171], v[64:67]
    ds_read_b64_tr_b16 v[166:167], v8 offset:2592
    v_mfma_f32_16x16x32_bf16 v[68:71], v[168:171], a[172:175], v[68:71]
    s_waitcnt lgkmcnt(2)
    buffer_load_dwordx4 a[236:239], v13, s[44:47], s73 offen offset:3072 sc1
    v_mfma_f32_16x16x32_bf16 v[72:75], v[168:171], a[176:179], v[72:75]
    ds_read_b64_tr_b16 v[168:169], v8 offset:128
    ds_read_b64_tr_b16 v[170:171], v8 offset:2688
    s_waitcnt vmcnt(12)
    v_mfma_f32_16x16x32_bf16 v[16:19], v[160:163], a[180:183], v[16:19]
    s_mov_b32 s62, 39
    ds_read_b32 v5, v4
    s_bfe_u32 s56, s19, 0x30018
    s_lshl_b32 s56, s56, 12
    s_add_u32 s73, s76, s56
    buffer_load_dwordx4 a[240:243], v11, s[44:47], s73 offen offset:0 sc1
    v_mfma_f32_16x16x32_bf16 v[20:23], v[160:163], a[184:187], v[20:23]
    s_waitcnt lgkmcnt(3)
    v_mfma_f32_16x16x32_bf16 v[24:27], v[160:163], a[188:191], v[24:27]
    ds_read_b64_tr_b16 v[160:161], v8 offset:5120
    v_mfma_f32_16x16x32_bf16 v[28:31], v[164:167], a[180:183], v[28:31]
    ds_read_b64_tr_b16 v[162:163], v8 offset:7680
    v_mfma_f32_16x16x32_bf16 v[32:35], v[164:167], a[184:187], v[32:35]
    s_waitcnt lgkmcnt(3)
    s_waitcnt lgkmcnt(2)
    v_cmp_gt_u32 vcc, s62, v5
    buffer_load_dwordx4 a[244:247], v12, s[44:47], s73 offen offset:0 sc1
    v_mfma_f32_16x16x32_bf16 v[36:39], v[164:167], a[188:191], v[36:39]
    ds_read_b64_tr_b16 v[164:165], v8 offset:5152
    v_mfma_f32_16x16x32_bf16 v[64:67], v[168:171], a[180:183], v[64:67]
    ds_read_b64_tr_b16 v[166:167], v8 offset:7712
    v_mfma_f32_16x16x32_bf16 v[68:71], v[168:171], a[184:187], v[68:71]
    s_cbranch_vccnz L_stub18
L_ret18:
    s_waitcnt lgkmcnt(2)
    buffer_load_dwordx4 a[248:251], v13, s[44:47], s73 offen offset:0 sc1
    v_mfma_f32_16x16x32_bf16 v[72:75], v[168:171], a[188:191], v[72:75]
    ds_read_b64_tr_b16 v[168:169], v8 offset:5248
    ds_read_b64_tr_b16 v[170:171], v8 offset:7808
    s_waitcnt vmcnt(12)
    v_mfma_f32_16x16x32_bf16 v[16:19], v[160:163], a[192:195], v[16:19]
    buffer_load_dwordx4 v[76:79], v11, s[44:47], s73 offen offset:1024 sc1
    v_mfma_f32_16x16x32_bf16 v[20:23], v[160:163], a[196:199], v[20:23]
    s_waitcnt lgkmcnt(2)
    v_mfma_f32_16x16x32_bf16 v[24:27], v[160:163], a[200:203], v[24:27]
    ds_read_b64_tr_b16 v[160:161], v8 offset:10240
    v_mfma_f32_16x16x32_bf16 v[28:31], v[164:167], a[192:195], v[28:31]
    ds_read_b64_tr_b16 v[162:163], v8 offset:12800
    v_mfma_f32_16x16x32_bf16 v[32:35], v[164:167], a[196:199], v[32:35]
    s_waitcnt lgkmcnt(2)
    buffer_load_dwordx4 v[80:83], v12, s[44:47], s73 offen offset:1024 sc1
    v_mfma_f32_16x16x32_bf16 v[36:39], v[164:167], a[200:203], v[36:39]
    ds_read_b64_tr_b16 v[164:165], v8 offset:10272
    v_mfma_f32_16x16x32_bf16 v[64:67], v[168:171], a[192:195], v[64:67]
    ds_read_b64_tr_b16 v[166:167], v8 offset:12832
    v_mfma_f32_16x16x32_bf16 v[68:71], v[168:171], a[196:199], v[68:71]
    s_waitcnt lgkmcnt(2)
    buffer_load_dwordx4 v[84:87], v13, s[44:47], s73 offen offset:1024 sc1
    v_mfma_f32_16x16x32_bf16 v[72:75], v[168:171], a[200:203], v[72:75]
    ds_read_b64_tr_b16 v[168:169], v8 offset:10368
    ds_read_b64_tr_b16 v[170:171], v8 offset:12928
    s_waitcnt vmcnt(12)
    v_mfma_f32_16x16x32_bf16 v[16:19], v[160:163], a[204:207], v[16:19]
    buffer_load_dwordx4 v[88:91], v11, s[44:47], s73 offen offset:2048 sc1
    v_mfma_f32_16x16x32_bf16 v[20:23], v[160:163], a[208:211], v[20:23]
    s_waitcnt lgkmcnt(2)
    v_mfma_f32_16x16x32_bf16 v[24:27], v[160:163], a[212:215], v[24:27]
    ds_read_b64_tr_b16 v[160:161], v8 offset:15360
    v_mfma_f32_16x16x32_bf16 v[28:31], v[164:167], a[204:207], v[28:31]
    ds_read_b64_tr_b16 v[162:163], v8 offset:17920
    v_mfma_f32_16x16x32_bf16 v[32:35], v[164:167], a[208:211], v[32:35]
    s_waitcnt lgkmcnt(2)
    buffer_load_dwordx4 v[92:95], v12, s[44:47], s73 offen offset:2048 sc1
    v_mfma_f32_16x16x32_bf16 v[36:39], v[164:167], a[212:215], v[36:39]
    ds_read_b64_tr_b16 v[164:165], v8 offset:15392
    v_mfma_f32_16x16x32_bf16 v[64:67], v[168:171], a[204:207], v[64:67]
    ds_read_b64_tr_b16 v[166:167], v8 offset:17952
    v_mfma_f32_16x16x32_bf16 v[68:71], v[168:171], a[208:211], v[68:71]
    s_waitcnt lgkmcnt(2)
    buffer_load_dwordx4 v[96:99], v13, s[44:47], s73 offen offset:2048 sc1
    v_mfma_f32_16x16x32_bf16 v[72:75], v[168:171], a[212:215], v[72:75]
    ds_read_b64_tr_b16 v[168:169], v8 offset:15488
    ds_read_b64_tr_b16 v[170:171], v8 offset:18048
    s_waitcnt vmcnt(12)
    v_mfma_f32_16x16x32_bf16 v[16:19], v[160:163], a[216:219], v[16:19]
    buffer_load_dwordx4 v[100:103], v11, s[44:47], s73 offen offset:3072 sc1
    v_mfma_f32_16x16x32_bf16 v[20:23], v[160:163], a[220:223], v[20:23]
    s_waitcnt lgkmcnt(2)
    v_mfma_f32_16x16x32_bf16 v[24:27], v[160:163], a[224:227], v[24:27]
    ds_read_b64_tr_b16 v[160:161], v8 offset:20480
    v_mfma_f32_16x16x32_bf16 v[28:31], v[164:167], a[216:219], v[28:31]
    ds_read_b64_tr_b16 v[162:163], v8 offset:23040
    v_mfma_f32_16x16x32_bf16 v[32:35], v[164:167], a[220:223], v[32:35]
    s_waitcnt lgkmcnt(2)
    buffer_load_dwordx4 v[104:107], v12, s[44:47], s73 offen offset:3072 sc1
    v_mfma_f32_16x16x32_bf16 v[36:39], v[164:167], a[224:227], v[36:39]
    ds_read_b64_tr_b16 v[164:165], v8 offset:20512
    v_mfma_f32_16x16x32_bf16 v[64:67], v[168:171], a[216:219], v[64:67]
    ds_read_b64_tr_b16 v[166:167], v8 offset:23072
    v_mfma_f32_16x16x32_bf16 v[68:71], v[168:171], a[220:223], v[68:71]
    s_waitcnt lgkmcnt(2)
    buffer_load_dwordx4 v[108:111], v13, s[44:47], s73 offen offset:3072 sc1
    v_mfma_f32_16x16x32_bf16 v[72:75], v[168:171], a[224:227], v[72:75]
    ds_read_b64_tr_b16 v[168:169], v8 offset:20608
    ds_read_b64_tr_b16 v[170:171], v8 offset:23168
    s_waitcnt vmcnt(12)
    v_mfma_f32_16x16x32_bf16 v[16:19], v[160:163], a[228:231], v[16:19]
    s_mov_b32 s62, 43
    ds_read_b32 v5, v4
    s_bfe_u32 s56, s19, 0x3001c
    s_lshl_b32 s56, s56, 12
    s_add_u32 s73, s76, s56
    buffer_load_dwordx4 v[112:115], v11, s[44:47], s73 offen offset:0 sc1
    v_mfma_f32_16x16x32_bf16 v[20:23], v[160:163], a[232:235], v[20:23]
    s_waitcnt lgkmcnt(3)
    v_mfma_f32_16x16x32_bf16 v[24:27], v[160:163], a[236:239], v[24:27]
    ds_read_b64_tr_b16 v[160:161], v8 offset:25600
    v_mfma_f32_16x16x32_bf16 v[28:31], v[164:167], a[228:231], v[28:31]
    ds_read_b64_tr_b16 v[162:163], v8 offset:28160
    v_mfma_f32_16x16x32_bf16 v[32:35], v[164:167], a[232:235], v[32:35]
    s_waitcnt lgkmcnt(3)
    s_waitcnt lgkmcnt(2)
    v_cmp_gt_u32 vcc, s62, v5
    buffer_load_dwordx4 v[116:119], v12, s[44:47], s73 offen offset:0 sc1
    v_mfma_f32_16x16x32_bf16 v[36:39], v[164:167], a[236:239], v[36:39]
    ds_read_b64_tr_b16 v[164:165], v8 offset:25632
    v_mfma_f32_16x16x32_bf16 v[64:67], v[168:171], a[228:231], v[64:67]
    ds_read_b64_tr_b16 v[166:167], v8 offset:28192
    v_mfma_f32_16x16x32_bf16 v[68:71], v[168:171], a[232:235], v[68:71]
    s_cbranch_vccnz L_stub19
L_ret19:
    s_waitcnt lgkmcnt(2)
    buffer_load_dwordx4 v[120:123], v13, s[44:47], s73 offen offset:0 sc1
    v_mfma_f32_16x16x32_bf16 v[72:75], v[168:171], a[236:239], v[72:75]
    ds_read_b64_tr_b16 v[168:169], v8 offset:25728
    ds_read_b64_tr_b16 v[170:171], v8 offset:28288
    s_waitcnt vmcnt(12)
    v_mfma_f32_16x16x32_bf16 v[16:19], v[160:163], a[240:243], v[16:19]
    buffer_load_dwordx4 v[124:127], v11, s[44:47], s73 offen offset:1024 sc1
    v_mfma_f32_16x16x32_bf16 v[20:23], v[160:163], a[244:247], v[20:23]
    s_waitcnt lgkmcnt(2)
    v_mfma_f32_16x16x32_bf16 v[24:27], v[160:163], a[248:251], v[24:27]
    ds_read_b64_tr_b16 v[160:161], v8 offset:30720
    v_mfma_f32_16x16x32_bf16 v[28:31], v[164:167], a[240:243], v[28:31]
    ds_read_b64_tr_b16 v[162:163], v8 offset:33280
    v_mfma_f32_16x16x32_bf16 v[32:35], v[164:167], a[244:247], v[32:35]
    s_waitcnt lgkmcnt(2)
    buffer_load_dwordx4 v[128:131], v12, s[44:47], s73 offen offset:1024 sc1
    v_mfma_f32_16x16x32_bf16 v[36:39], v[164:167], a[248:251], v[36:39]
    ds_read_b64_tr_b16 v[164:165], v8 offset:30752
    v_mfma_f32_16x16x32_bf16 v[64:67], v[168:171], a[240:243], v[64:67]
    ds_read_b64_tr_b16 v[166:167], v8 offset:33312
    v_mfma_f32_16x16x32_bf16 v[68:71], v[168:171], a[244:247], v[68:71]
    s_waitcnt lgkmcnt(2)
    buffer_load_dwordx4 v[132:135], v13, s[44:47], s73 offen offset:1024 sc1
    v_mfma_f32_16x16x32_bf16 v[72:75], v[168:171], a[248:251], v[72:75]
    ds_read_b64_tr_b16 v[168:169], v8 offset:30848
    ds_read_b64_tr_b16 v[170:171], v8 offset:33408
    s_waitcnt vmcnt(12)
    v_mfma_f32_16x16x32_bf16 v[16:19], v[160:163], v[76:79], v[16:19]
    buffer_load_dwordx4 v[136:139], v11, s[44:47], s73 offen offset:2048 sc1
    v_mfma_f32_16x16x32_bf16 v[20:23], v[160:163], v[80:83], v[20:23]
    s_waitcnt lgkmcnt(2)
    v_mfma_f32_16x16x32_bf16 v[24:27], v[160:163], v[84:87], v[24:27]
    ds_read_b64_tr_b16 v[160:161], v8 offset:35840
    v_mfma_f32_16x16x32_bf16 v[28:31], v[164:167], v[76:79], v[28:31]
    ds_read_b64_tr_b16 v[162:163], v8 offset:38400
    v_mfma_f32_16x16x32_bf16 v[32:35], v[164:167], v[80:83], v[32:35]
    s_waitcnt lgkmcnt(2)
    buffer_load_dwordx4 v[140:143], v12, s[44:47], s73 offen offset:2048 sc1
    v_mfma_f32_16x16x32_bf16 v[36:39], v[164:167], v[84:87], v[36:39]
    ds_read_b64_tr_b16 v[164:165], v8 offset:35872
    v_mfma_f32_16x16x32_bf16 v[64:67], v[168:171], v[76:79], v[64:67]
    ds_read_b64_tr_b16 v[166:167], v8 offset:38432
    v_mfma_f32_16x16x32_bf16 v[68:71], v[168:171], v[80:83], v[68:71]
    s_waitcnt lgkmcnt(2)
    buffer_load_dwordx4 v[144:147], v13, s[44:47], s73 offen offset:2048 sc1
    v_mfma_f32_16x16x32_bf16 v[72:75], v[168:171], v[84:87], v[72:75]
    ds_read_b64_tr_b16 v[168:169], v8 offset:35968
    ds_read_b64_tr_b16 v[170:171], v8 offset:38528
    s_waitcnt vmcnt(12)
    v_mfma_f32_16x16x32_bf16 v[16:19], v[160:163], v[88:91], v[16:19]
    buffer_load_dwordx4 v[148:151], v11, s[44:47], s73 offen offset:3072 sc1
    v_mfma_f32_16x16x32_bf16 v[20:23], v[160:163], v[92:95], v[20:23]
    s_waitcnt lgkmcnt(2)
    v_mfma_f32_16x16x32_bf16 v[24:27], v[160:163], v[96:99], v[24:27]
    ds_read_b64_tr_b16 v[160:161], v8 offset:40960
    v_mfma_f32_16x16x32_bf16 v[28:31], v[164:167], v[88:91], v[28:31]
    ds_read_b64_tr_b16 v[162:163], v8 offset:43520
    v_mfma_f32_16x16x32_bf16 v[32:35], v[164:167], v[92:95], v[32:35]
    s_waitcnt lgkmcnt(2)
    buffer_load_dwordx4 v[152:155], v12, s[44:47], s73 offen offset:3072 sc1
    v_mfma_f32_16x16x32_bf16 v[36:39], v[164:167], v[96:99], v[36:39]
    ds_read_b64_tr_b16 v[164:165], v8 offset:40992
    v_mfma_f32_16x16x32_bf16 v[64:67], v[168:171], v[88:91], v[64:67]
    ds_read_b64_tr_b16 v[166:167], v8 offset:43552
    v_mfma_f32_16x16x32_bf16 v[68:71], v[168:171], v[92:95], v[68:71]
    s_waitcnt lgkmcnt(2)
    buffer_load_dwordx4 v[156:159], v13, s[44:47], s73 offen offset:3072 sc1
    v_mfma_f32_16x16x32_bf16 v[72:75], v[168:171], v[96:99], v[72:75]
    ds_read_b64_tr_b16 v[168:169], v8 offset:41088
    ds_read_b64_tr_b16 v[170:171], v8 offset:43648
    s_waitcnt vmcnt(12)
    v_mfma_f32_16x16x32_bf16 v[16:19], v[160:163], v[100:103], v[16:19]
    s_mov_b32 s62, 46
    ds_read_b32 v5, v4
    v_mfma_f32_16x16x32_bf16 v[20:23], v[160:163], v[104:107], v[20:23]
    s_waitcnt lgkmcnt(3)
    v_mfma_f32_16x16x32_bf16 v[24:27], v[160:163], v[108:111], v[24:27]
    ds_read_b64_tr_b16 v[160:161], v8 offset:46080
    v_mfma_f32_16x16x32_bf16 v[28:31], v[164:167], v[100:103], v[28:31]
    ds_read_b64_tr_b16 v[162:163], v8 offset:48640
    v_mfma_f32_16x16x32_bf16 v[32:35], v[164:167], v[104:107], v[32:35]
    s_waitcnt lgkmcnt(3)
    s_waitcnt lgkmcnt(2)
    v_cmp_gt_u32 vcc, s62, v5
    v_mfma_f32_16x16x32_bf16 v[36:39], v[164:167], v[108:111], v[36:39]
    ds_read_b64_tr_b16 v[164:165], v8 offset:46112
    v_mfma_f32_16x16x32_bf16 v[64:67], v[168:171], v[100:103], v[64:67]
    ds_read_b64_tr_b16 v[166:167], v8 offset:48672
    v_mfma_f32_16x16x32_bf16 v[68:71], v[168:171], v[104:107], v[68:71]
    s_cbranch_vccnz L_stub20
L_ret20:
    s_waitcnt lgkmcnt(2)
    v_mfma_f32_16x16x32_bf16 v[72:75], v[168:171], v[108:111], v[72:75]
    ds_read_b64_tr_b16 v[168:169], v8 offset:46208
    ds_read_b64_tr_b16 v[170:171], v8 offset:48768
    s_waitcnt vmcnt(9)
    v_mfma_f32_16x16x32_bf16 v[16:19], v[160:163], v[112:115], v[16:19]
    v_mfma_f32_16x16x32_bf16 v[20:23], v[160:163], v[116:119], v[20:23]
    s_waitcnt lgkmcnt(2)
    v_mfma_f32_16x16x32_bf16 v[24:27], v[160:163], v[120:123], v[24:27]
    ds_read_b64_tr_b16 v[160:161], v8 offset:51200
    v_mfma_f32_16x16x32_bf16 v[28:31], v[164:167], v[112:115], v[28:31]
    ds_read_b64_tr_b16 v[162:163], v8 offset:53760
    v_mfma_f32_16x16x32_bf16 v[32:35], v[164:167], v[116:119], v[32:35]
    s_waitcnt lgkmcnt(2)
    v_mfma_f32_16x16x32_bf16 v[36:39], v[164:167], v[120:123], v[36:39]
    ds_read_b64_tr_b16 v[164:165], v8 offset:51232
    v_mfma_f32_16x16x32_bf16 v[64:67], v[168:171], v[112:115], v[64:67]
    ds_read_b64_tr_b16 v[166:167], v8 offset:53792
    v_mfma_f32_16x16x32_bf16 v[68:71], v[168:171], v[116:119], v[68:71]
    s_waitcnt lgkmcnt(2)
    v_mfma_f32_16x16x32_bf16 v[72:75], v[168:171], v[120:123], v[72:75]
    ds_read_b64_tr_b16 v[168:169], v8 offset:51328
    ds_read_b64_tr_b16 v[170:171], v8 offset:53888
    s_waitcnt vmcnt(6)
    v_mfma_f32_16x16x32_bf16 v[16:19], v[160:163], v[124:127], v[16:19]
    v_mfma_f32_16x16x32_bf16 v[20:23], v[160:163], v[128:131], v[20:23]
    s_waitcnt lgkmcnt(2)
    v_mfma_f32_16x16x32_bf16 v[24:27], v[160:163], v[132:135], v[24:27]
    ds_read_b64_tr_b16 v[160:161], v8 offset:56320
    v_mfma_f32_16x16x32_bf16 v[28:31], v[164:167], v[124:127], v[28:31]
    ds_read_b64_tr_b16 v[162:163], v8 offset:58880
    v_mfma_f32_16x16x32_bf16 v[32:35], v[164:167], v[128:131], v[32:35]
    s_waitcnt lgkmcnt(2)
    v_mfma_f32_16x16x32_bf16 v[36:39], v[164:167], v[132:135], v[36:39]
    ds_read_b64_tr_b16 v[164:165], v8 offset:56352
    v_mfma_f32_16x16x32_bf16 v[64:67], v[168:171], v[124:127], v[64:67]
    ds_read_b64_tr_b16 v[166:167], v8 offset:58912
    v_mfma_f32_16x16x32_bf16 v[68:71], v[168:171], v[128:131], v[68:71]
    s_waitcnt lgkmcnt(2)
    v_mfma_f32_16x16x32_bf16 v[72:75], v[168:171], v[132:135], v[72:75]
    ds_read_b64_tr_b16 v[168:169], v8 offset:56448
    ds_read_b64_tr_b16 v[170:171], v8 offset:59008
    s_waitcnt vmcnt(3)
    v_mfma_f32_16x16x32_bf16 v[16:19], v[160:163], v[136:139], v[16:19]
    v_mfma_f32_16x16x32_bf16 v[20:23], v[160:163], v[140:143], v[20:23]
    s_waitcnt lgkmcnt(2)
    v_mfma_f32_16x16x32_bf16 v[24:27], v[160:163], v[144:147], v[24:27]
    ds_read_b64_tr_b16 v[160:161], v10 offset:5120
    v_mfma_f32_16x16x32_bf16 v[28:31], v[164:167], v[136:139], v[28:31]
    ds_read_b64_tr_b16 v[162:163], v10 offset:7680
    v_mfma_f32_16x16x32_bf16 v[32:35], v[164:167], v[140:143], v[32:35]
    s_waitcnt lgkmcnt(2)
    v_mfma_f32_16x16x32_bf16 v[36:39], v[164:167], v[144:147], v[36:39]
    ds_read_b64_tr_b16 v[164:165], v10 offset:5152
    v_mfma_f32_16x16x32_bf16 v[64:67], v[168:171], v[136:139], v[64:67]
    ds_read_b64_tr_b16 v[166:167], v10 offset:7712
    v_mfma_f32_16x16x32_bf16 v[68:71], v[168:171], v[140:143], v[68:71]
    s_waitcnt lgkmcnt(2)
    v_mfma_f32_16x16x32_bf16 v[72:75], v[168:171], v[144:147], v[72:75]
    ds_read_b64_tr_b16 v[168:169], v10 offset:5248
    ds_read_b64_tr_b16 v[170:171], v10 offset:7808
    s_waitcnt vmcnt(0)
    v_mfma_f32_16x16x32_bf16 v[16:19], v[160:163], v[148:151], v[16:19]
    ds_read_b64_tr_b16 v[172:173], v10 offset:25664
    ds_read_b64_tr_b16 v[174:175], v10 offset:28224
    ds_read_b64_tr_b16 v[176:177], v10 offset:30784
    ds_read_b64_tr_b16 v[178:179], v10 offset:33344
    v_mfma_f32_16x16x32_bf16 v[20:23], v[160:163], v[152:155], v[20:23]
    s_waitcnt lgkmcnt(6)
    v_mfma_f32_16x16x32_bf16 v[24:27], v[160:163], v[156:159], v[24:27]
    ds_read_b64_tr_b16 v[160:161], v9 offset:64
    ds_read_b64_tr_b16 v[162:163], v9 offset:2624
    v_mfma_f32_16x16x32_bf16 v[28:31], v[164:167], v[148:151], v[28:31]
    v_mfma_f32_16x16x32_bf16 v[32:35], v[164:167], v[152:155], v[32:35]
    s_waitcnt lgkmcnt(6)
    v_mfma_f32_16x16x32_bf16 v[36:39], v[164:167], v[156:159], v[36:39]
    ds_read_b64_tr_b16 v[164:165], v9 offset:5184
    ds_read_b64_tr_b16 v[166:167], v9 offset:7744
    v_mfma_f32_16x16x32_bf16 v[64:67], v[168:171], v[148:151], v[64:67]
    v_mfma_f32_16x16x32_bf16 v[68:71], v[168:171], v[152:155], v[68:71]
    s_waitcnt lgkmcnt(2)
    v_mfma_f32_16x16x32_bf16 v[72:75], v[168:171], v[156:159], v[72:75]
    v_mfma_f32_16x16x32_bf16 v[40:43], v[172:175], a[0:3], v[40:43]
    ds_read_b64_tr_b16 v[168:169], v9 offset:10304
    ds_read_b64_tr_b16 v[170:171], v9 offset:12864
    v_mfma_f32_16x16x32_bf16 v[44:47], v[172:175], a[4:7], v[44:47]
    v_mfma_f32_16x16x32_bf16 v[48:51], v[172:175], a[8:11], v[48:51]
    v_mfma_f32_16x16x32_bf16 v[40:43], v[176:179], a[12:15], v[40:43]
    ds_read_b64_tr_b16 v[172:173], v9 offset:15424
    ds_read_b64_tr_b16 v[174:175], v9 offset:17984
    v_mfma_f32_16x16x32_bf16 v[44:47], v[176:179], a[16:19], v[44:47]
    s_add_u32 s55, s65, 1
    v_cvt_pk_bf16_f32 v180, v16, v17
    v_cvt_pk_bf16_f32 v181, v18, v19
    v_mfma_f32_16x16x32_bf16 v[48:51], v[176:179], a[20:23], v[48:51]
    s_and_b32 s55, s55, 3
    v_cvt_pk_bf16_f32 v182, v20, v21
    v_cvt_pk_bf16_f32 v184, v22, v23
    v_mfma_f32_16x16x32_bf16 v[40:43], v[160:163], a[24:27], v[40:43]
    ds_read_b64_tr_b16 v[176:177], v9 offset:20544
    ds_read_b64_tr_b16 v[178:179], v9 offset:23104
    v_mfma_f32_16x16x32_bf16 v[44:47], v[160:163], a[28:31], v[44:47]
    s_mul_i32 s55, s55, 49152
    v_cvt_pk_bf16_f32 v185, v24, v25
    v_cvt_pk_bf16_f32 v186, v26, v27
    v_mfma_f32_16x16x32_bf16 v[48:51], v[160:163], a[32:35], v[48:51]
    s_waitcnt lgkmcnt(6)
    s_add_u32 s55, s55, s72
    buffer_store_dwordx4 v[180:183], v1, s[44:47], s55 offen offset:0 sc1
    v_mfma_f32_16x16x32_bf16 v[40:43], v[164:167], a[36:39], v[40:43]
    ds_read_b64_tr_b16 v[160:161], v9 offset:25664
    ds_read_b64_tr_b16 v[162:163], v9 offset:28224
    v_mfma_f32_16x16x32_bf16 v[44:47], v[164:167], a[40:43], v[44:47]
    buffer_store_dwordx4 v[184:187], v1, s[44:47], s55 offen offset:1024 sc1
    v_mfma_f32_16x16x32_bf16 v[48:51], v[164:167], a[44:47], v[48:51]
    s_waitcnt lgkmcnt(6)
    s_add_u32 s55, s65, 2
    v_cvt_pk_bf16_f32 v188, v28, v29
    v_cvt_pk_bf16_f32 v189, v30, v31
    v_mfma_f32_16x16x32_bf16 v[40:43], v[168:171], a[48:51], v[40:43]
    ds_read_b64_tr_b16 v[164:165], v9 offset:30784
    ds_read_b64_tr_b16 v[166:167], v9 offset:33344
    v_mfma_f32_16x16x32_bf16 v[44:47], v[168:171], a[52:55], v[44:47]
    s_and_b32 s55, s55, 3
    v_cvt_pk_bf16_f32 v190, v32, v33
    v_cvt_pk_bf16_f32 v192, v34, v35
    v_mfma_f32_16x16x32_bf16 v[48:51], v[168:171], a[56:59], v[48:51]
    s_waitcnt lgkmcnt(6)
    s_mul_i32 s55, s55, 49152
    v_cvt_pk_bf16_f32 v193, v36, v37
    v_cvt_pk_bf16_f32 v194, v38, v39
    v_mfma_f32_16x16x32_bf16 v[40:43], v[172:175], a[60:63], v[40:43]
    ds_read_b64_tr_b16 v[168:169], v9 offset:35904
    ds_read_b64_tr_b16 v[170:171], v9 offset:38464
    v_mfma_f32_16x16x32_bf16 v[44:47], v[172:175], a[64:67], v[44:47]
    s_add_u32 s55, s55, s72
    buffer_store_dwordx4 v[188:191], v1, s[44:47], s55 offen offset:0 sc1
    v_mfma_f32_16x16x32_bf16 v[48:51], v[172:175], a[68:71], v[48:51]
    s_waitcnt lgkmcnt(6)
    buffer_store_dwordx4 v[192:195], v1, s[44:47], s55 offen offset:1024 sc1
    v_mfma_f32_16x16x32_bf16 v[40:43], v[176:179], a[72:75], v[40:43]
    ds_read_b64_tr_b16 v[172:173], v9 offset:41024
    ds_read_b64_tr_b16 v[174:175], v9 offset:43584
    v_mfma_f32_16x16x32_bf16 v[44:47], v[176:179], a[76:79], v[44:47]
    s_add_u32 s55, s72, 0
    v_cvt_pk_bf16_f32 v204, v64, v65
    v_cvt_pk_bf16_f32 v205, v66, v67
    v_mfma_f32_16x16x32_bf16 v[48:51], v[176:179], a[80:83], v[48:51]
    s_waitcnt lgkmcnt(6)
    buffer_store_dwordx4 v[204:207], v1, s[44:47], s55 offen offset:2048 sc1
    v_mfma_f32_16x16x32_bf16 v[40:43], v[160:163], a[84:87], v[40:43]
    ds_read_b64_tr_b16 v[176:177], v9 offset:46144
    ds_read_b64_tr_b16 v[178:179], v9 offset:48704
    v_mfma_f32_16x16x32_bf16 v[44:47], v[160:163], a[88:91], v[44:47]
    s_add_u32 s55, s72, 49152
    v_cvt_pk_bf16_f32 v208, v68, v69
    v_cvt_pk_bf16_f32 v209, v70, v71
    v_mfma_f32_16x16x32_bf16 v[48:51], v[160:163], a[92:95], v[48:51]
    s_waitcnt lgkmcnt(6)
    buffer_store_dwordx4 v[208:211], v1, s[44:47], s55 offen offset:2048 sc1
    v_mfma_f32_16x16x32_bf16 v[40:43], v[164:167], a[96:99], v[40:43]
    ds_read_b64_tr_b16 v[160:161], v9 offset:51264
    ds_read_b64_tr_b16 v[162:163], v9 offset:53824
    v_mfma_f32_16x16x32_bf16 v[44:47], v[164:167], a[100:103], v[44:47]
    s_add_u32 s55, s72, 98304
    v_cvt_pk_bf16_f32 v212, v72, v73
    v_cvt_pk_bf16_f32 v213, v74, v75
    v_mfma_f32_16x16x32_bf16 v[48:51], v[164:167], a[104:107], v[48:51]
    s_waitcnt lgkmcnt(6)
    buffer_store_dwordx4 v[212:215], v1, s[44:47], s55 offen offset:2048 sc1
    v_mfma_f32_16x16x32_bf16 v[40:43], v[168:171], a[108:111], v[40:43]
    ds_read_b64_tr_b16 v[164:165], v9 offset:56384
    ds_read_b64_tr_b16 v[166:167], v9 offset:58944
    v_mfma_f32_16x16x32_bf16 v[44:47], v[168:171], a[112:115], v[44:47]
    v_mfma_f32_16x16x32_bf16 v[48:51], v[168:171], a[116:119], v[48:51]
    s_waitcnt lgkmcnt(6)
    v_mfma_f32_16x16x32_bf16 v[40:43], v[172:175], a[120:123], v[40:43]
    ds_read_b64_tr_b16 v[168:169], v10 offset:64
    ds_read_b64_tr_b16 v[170:171], v10 offset:2624
    v_mfma_f32_16x16x32_bf16 v[44:47], v[172:175], a[124:127], v[44:47]
    v_mfma_f32_16x16x32_bf16 v[48:51], v[172:175], a[128:131], v[48:51]
    s_waitcnt lgkmcnt(6)
    v_mfma_f32_16x16x32_bf16 v[40:43], v[176:179], a[132:135], v[40:43]
    ds_read_b64_tr_b16 v[172:173], v8 offset:64
    ds_read_b64_tr_b16 v[174:175], v8 offset:2624
    v_mfma_f32_16x16x32_bf16 v[44:47], v[176:179], a[136:139], v[44:47]
    v_mfma_f32_16x16x32_bf16 v[48:51], v[176:179], a[140:143], v[48:51]
    s_waitcnt lgkmcnt(6)
    v_mfma_f32_16x16x32_bf16 v[40:43], v[160:163], a[144:147], v[40:43]
    ds_read_b64_tr_b16 v[176:177], v8 offset:5184
    ds_read_b64_tr_b16 v[178:179], v8 offset:7744
    v_mfma_f32_16x16x32_bf16 v[44:47], v[160:163], a[148:151], v[44:47]
    v_mfma_f32_16x16x32_bf16 v[48:51], v[160:163], a[152:155], v[48:51]
    s_waitcnt lgkmcnt(6)
    v_mfma_f32_16x16x32_bf16 v[40:43], v[164:167], a[156:159], v[40:43]
    ds_read_b64_tr_b16 v[160:161], v8 offset:10304
    ds_read_b64_tr_b16 v[162:163], v8 offset:12864
    v_mfma_f32_16x16x32_bf16 v[44:47], v[164:167], a[160:163], v[44:47]
    v_mfma_f32_16x16x32_bf16 v[48:51], v[164:167], a[164:167], v[48:51]
    s_waitcnt lgkmcnt(6)
    v_mfma_f32_16x16x32_bf16 v[40:43], v[168:171], a[168:171], v[40:43]
    ds_read_b64_tr_b16 v[164:165], v8 offset:15424
    ds_read_b64_tr_b16 v[166:167], v8 offset:17984
    v_mfma_f32_16x16x32_bf16 v[44:47], v[168:171], a[172:175], v[44:47]
    v_mfma_f32_16x16x32_bf16 v[48:51], v[168:171], a[176:179], v[48:51]
    s_waitcnt lgkmcnt(6)
    v_mfma_f32_16x16x32_bf16 v[40:43], v[172:175], a[180:183], v[40:43]
    ds_read_b64_tr_b16 v[168:169], v8 offset:20544
    ds_read_b64_tr_b16 v[170:171], v8 offset:23104
    v_mfma_f32_16x16x32_bf16 v[44:47], v[172:175], a[184:187], v[44:47]
    v_mfma_f32_16x16x32_bf16 v[48:51], v[172:175], a[188:191], v[48:51]
    s_waitcnt lgkmcnt(6)
    v_mfma_f32_16x16x32_bf16 v[40:43], v[176:179], a[192:195], v[40:43]
    ds_read_b64_tr_b16 v[172:173], v8 offset:25664
    ds_read_b64_tr_b16 v[174:175], v8 offset:28224
    v_mfma_f32_16x16x32_bf16 v[44:47], v[176:179], a[196:199], v[44:47]
    v_mfma_f32_16x16x32_bf16 v[48:51], v[176:179], a[200:203], v[48:51]
    s_waitcnt lgkmcnt(6)
    v_mfma_f32_16x16x32_bf16 v[40:43], v[160:163], a[204:207], v[40:43]
    ds_read_b64_tr_b16 v[176:177], v8 offset:30784
    ds_read_b64_tr_b16 v[178:179], v8 offset:33344
    v_mfma_f32_16x16x32_bf16 v[44:47], v[160:163], a[208:211], v[44:47]
    v_mfma_f32_16x16x32_bf16 v[48:51], v[160:163], a[212:215], v[48:51]
    s_waitcnt lgkmcnt(6)
    v_mfma_f32_16x16x32_bf16 v[40:43], v[164:167], a[216:219], v[40:43]
    ds_read_b64_tr_b16 v[160:161], v8 offset:35904
    ds_read_b64_tr_b16 v[162:163], v8 offset:38464
    v_mfma_f32_16x16x32_bf16 v[44:47], v[164:167], a[220:223], v[44:47]
    v_mfma_f32_16x16x32_bf16 v[48:51], v[164:167], a[224:227], v[48:51]
    s_waitcnt lgkmcnt(6)
    v_mfma_f32_16x16x32_bf16 v[40:43], v[168:171], a[228:231], v[40:43]
    ds_read_b64_tr_b16 v[164:165], v8 offset:41024
    ds_read_b64_tr_b16 v[166:167], v8 offset:43584
    v_mfma_f32_16x16x32_bf16 v[44:47], v[168:171], a[232:235], v[44:47]
    v_mfma_f32_16x16x32_bf16 v[48:51], v[168:171], a[236:239], v[48:51]
    s_waitcnt lgkmcnt(6)
    v_mfma_f32_16x16x32_bf16 v[40:43], v[172:175], a[240:243], v[40:43]
    ds_read_b64_tr_b16 v[168:169], v8 offset:46144
    ds_read_b64_tr_b16 v[170:171], v8 offset:48704
    v_mfma_f32_16x16x32_bf16 v[44:47], v[172:175], a[244:247], v[44:47]
    v_mfma_f32_16x16x32_bf16 v[48:51], v[172:175], a[248:251], v[48:51]
    s_waitcnt lgkmcnt(6)
    v_mfma_f32_16x16x32_bf16 v[40:43], v[176:179], v[76:79], v[40:43]
    ds_read_b64_tr_b16 v[172:173], v8 offset:51264
    ds_read_b64_tr_b16 v[174:175], v8 offset:53824
    v_mfma_f32_16x16x32_bf16 v[44:47], v[176:179], v[80:83], v[44:47]
    v_mfma_f32_16x16x32_bf16 v[48:51], v[176:179], v[84:87], v[48:51]
    s_waitcnt lgkmcnt(6)
    v_mfma_f32_16x16x32_bf16 v[40:43], v[160:163], v[88:91], v[40:43]
    ds_read_b64_tr_b16 v[176:177], v8 offset:56384
    ds_read_b64_tr_b16 v[178:179], v8 offset:58944
    v_mfma_f32_16x16x32_bf16 v[44:47], v[160:163], v[92:95], v[44:47]
    v_mfma_f32_16x16x32_bf16 v[48:51], v[160:163], v[96:99], v[48:51]
    s_waitcnt lgkmcnt(6)
    v_mfma_f32_16x16x32_bf16 v[40:43], v[164:167], v[100:103], v[40:43]
    ds_read_b64_tr_b16 v[160:161], v10 offset:5184
    ds_read_b64_tr_b16 v[162:163], v10 offset:7744
    v_mfma_f32_16x16x32_bf16 v[44:47], v[164:167], v[104:107], v[44:47]
    v_mfma_f32_16x16x32_bf16 v[48:51], v[164:167], v[108:111], v[48:51]
    s_waitcnt lgkmcnt(6)
    v_mfma_f32_16x16x32_bf16 v[40:43], v[168:171], v[112:115], v[40:43]
    ds_read_b64_tr_b16 v[164:165], v10 offset:25696
    ds_read_b64_tr_b16 v[166:167], v10 offset:28256
    v_mfma_f32_16x16x32_bf16 v[44:47], v[168:171], v[116:119], v[44:47]
    v_mfma_f32_16x16x32_bf16 v[48:51], v[168:171], v[120:123], v[48:51]
    s_waitcnt lgkmcnt(6)
    v_mfma_f32_16x16x32_bf16 v[40:43], v[172:175], v[124:127], v[40:43]
    ds_read_b64_tr_b16 v[168:169], v10 offset:30816
    ds_read_b64_tr_b16 v[170:171], v10 offset:33376
    v_mfma_f32_16x16x32_bf16 v[44:47], v[172:175], v[128:131], v[44:47]
    v_mfma_f32_16x16x32_bf16 v[48:51], v[172:175], v[132:135], v[48:51]
    s_waitcnt lgkmcnt(6)
    v_mfma_f32_16x16x32_bf16 v[40:43], v[176:179], v[136:139], v[40:43]
    ds_read_b64_tr_b16 v[172:173], v9 offset:96
    ds_read_b64_tr_b16 v[174:175], v9 offset:2656
    v_mfma_f32_16x16x32_bf16 v[44:47], v[176:179], v[140:143], v[44:47]
    v_mfma_f32_16x16x32_bf16 v[48:51], v[176:179], v[144:147], v[48:51]
    s_waitcnt lgkmcnt(6)
    v_mfma_f32_16x16x32_bf16 v[40:43], v[160:163], v[148:151], v[40:43]
    ds_read_b64_tr_b16 v[176:177], v9 offset:5216
    ds_read_b64_tr_b16 v[178:179], v9 offset:7776
    v_mfma_f32_16x16x32_bf16 v[44:47], v[160:163], v[152:155], v[44:47]
    v_mfma_f32_16x16x32_bf16 v[48:51], v[160:163], v[156:159], v[48:51]
    s_waitcnt lgkmcnt(6)
    v_mfma_f32_16x16x32_bf16 v[52:55], v[164:167], a[0:3], v[52:55]
    ds_read_b64_tr_b16 v[160:161], v9 offset:10336
    ds_read_b64_tr_b16 v[162:163], v9 offset:12896
    v_mfma_f32_16x16x32_bf16 v[56:59], v[164:167], a[4:7], v[56:59]
    v_mfma_f32_16x16x32_bf16 v[60:63], v[164:167], a[8:11], v[60:63]
    s_waitcnt lgkmcnt(6)
    v_mfma_f32_16x16x32_bf16 v[52:55], v[168:171], a[12:15], v[52:55]
    ds_read_b64_tr_b16 v[164:165], v9 offset:15456
    ds_read_b64_tr_b16 v[166:167], v9 offset:18016
    v_mfma_f32_16x16x32_bf16 v[56:59], v[168:171], a[16:19], v[56:59]
    s_add_u32 s55, s65, 3
    v_cvt_pk_bf16_f32 v196, v40, v41
    v_cvt_pk_bf16_f32 v197, v42, v43
    v_mfma_f32_16x16x32_bf16 v[60:63], v[168:171], a[20:23], v[60:63]
    s_waitcnt lgkmcnt(6)
    s_and_b32 s55, s55, 3
    v_cvt_pk_bf16_f32 v198, v44, v45
    v_cvt_pk_bf16_f32 v200, v46, v47
    v_mfma_f32_16x16x32_bf16 v[52:55], v[172:175], a[24:27], v[52:55]
    ds_read_b64_tr_b16 v[168:169], v9 offset:20576
    ds_read_b64_tr_b16 v[170:171], v9 offset:23136
    v_mfma_f32_16x16x32_bf16 v[56:59], v[172:175], a[28:31], v[56:59]
    s_mul_i32 s55, s55, 49152
    v_cvt_pk_bf16_f32 v201, v48, v49
    v_cvt_pk_bf16_f32 v202, v50, v51
    v_mfma_f32_16x16x32_bf16 v[60:63], v[172:175], a[32:35], v[60:63]
    s_waitcnt lgkmcnt(6)
    s_add_u32 s55, s55, s72
    buffer_store_dwordx4 v[196:199], v1, s[44:47], s55 offen offset:0 sc1
    v_mfma_f32_16x16x32_bf16 v[52:55], v[176:179], a[36:39], v[52:55]
    ds_read_b64_tr_b16 v[172:173], v9 offset:25696
    ds_read_b64_tr_b16 v[174:175], v9 offset:28256
    v_mfma_f32_16x16x32_bf16 v[56:59], v[176:179], a[40:43], v[56:59]
    buffer_store_dwordx4 v[200:203], v1, s[44:47], s55 offen offset:1024 sc1
    v_mfma_f32_16x16x32_bf16 v[60:63], v[176:179], a[44:47], v[60:63]
    s_waitcnt lgkmcnt(6)
    v_mfma_f32_16x16x32_bf16 v[52:55], v[160:163], a[48:51], v[52:55]
    ds_read_b64_tr_b16 v[176:177], v9 offset:30816
    ds_read_b64_tr_b16 v[178:179], v9 offset:33376
    v_mfma_f32_16x16x32_bf16 v[56:59], v[160:163], a[52:55], v[56:59]
    v_mfma_f32_16x16x32_bf16 v[60:63], v[160:163], a[56:59], v[60:63]
    s_waitcnt lgkmcnt(6)
    v_mfma_f32_16x16x32_bf16 v[52:55], v[164:167], a[60:63], v[52:55]
    ds_read_b64_tr_b16 v[160:161], v9 offset:35936
    ds_read_b64_tr_b16 v[162:163], v9 offset:38496
    v_mfma_f32_16x16x32_bf16 v[56:59], v[164:167], a[64:67], v[56:59]
    v_mfma_f32_16x16x32_bf16 v[60:63], v[164:167], a[68:71], v[60:63]
    s_waitcnt lgkmcnt(6)
    v_mfma_f32_16x16x32_bf16 v[52:55], v[168:171], a[72:75], v[52:55]
    ds_read_b64_tr_b16 v[164:165], v9 offset:41056
    ds_read_b64_tr_b16 v[166:167], v9 offset:43616
    v_mfma_f32_16x16x32_bf16 v[56:59], v[168:171], a[76:79], v[56:59]
    v_mfma_f32_16x16x32_bf16 v[60:63], v[168:171], a[80:83], v[60:63]
    s_waitcnt lgkmcnt(6)
    v_mfma_f32_16x16x32_bf16 v[52:55], v[172:175], a[84:87], v[52:55]
    ds_read_b64_tr_b16 v[168:169], v9 offset:46176
    ds_read_b64_tr_b16 v[170:171], v9 offset:48736
    v_mfma_f32_16x16x32_bf16 v[56:59], v[172:175], a[88:91], v[56:59]
    v_mfma_f32_16x16x32_bf16 v[60:63], v[172:175], a[92:95], v[60:63]
    s_waitcnt lgkmcnt(6)
    v_mfma_f32_16x16x32_bf16 v[52:55], v[176:179], a[96:99], v[52:55]
    ds_read_b64_tr_b16 v[172:173], v9 offset:51296
    ds_read_b64_tr_b16 v[174:175], v9 offset:53856
    v_mfma_f32_16x16x32_bf16 v[56:59], v[176:179], a[100:103], v[56:59]
    v_mfma_f32_16x16x32_bf16 v[60:63], v[176:179], a[104:107], v[60:63]
    s_waitcnt lgkmcnt(6)
    v_mfma_f32_16x16x32_bf16 v[52:55], v[160:163], a[108:111], v[52:55]
    ds_read_b64_tr_b16 v[176:177], v9 offset:56416
    ds_read_b64_tr_b16 v[178:179], v9 offset:58976
    v_mfma_f32_16x16x32_bf16 v[56:59], v[160:163], a[112:115], v[56:59]
    v_mfma_f32_16x16x32_bf16 v[60:63], v[160:163], a[116:119], v[60:63]
    s_waitcnt lgkmcnt(6)
    v_mfma_f32_16x16x32_bf16 v[52:55], v[164:167], a[120:123], v[52:55]
    ds_read_b64_tr_b16 v[160:161], v10 offset:96
    ds_read_b64_tr_b16 v[162:163], v10 offset:2656
    v_mfma_f32_16x16x32_bf16 v[56:59], v[164:167], a[124:127], v[56:59]
    v_mfma_f32_16x16x32_bf16 v[60:63], v[164:167], a[128:131], v[60:63]
    s_waitcnt lgkmcnt(6)
    v_mfma_f32_16x16x32_bf16 v[52:55], v[168:171], a[132:135], v[52:55]
    ds_read_b64_tr_b16 v[164:165], v8 offset:96
    ds_read_b64_tr_b16 v[166:167], v8 offset:2656
    v_mfma_f32_16x16x32_bf16 v[56:59], v[168:171], a[136:139], v[56:59]
    v_mfma_f32_16x16x32_bf16 v[60:63], v[168:171], a[140:143], v[60:63]
    s_waitcnt lgkmcnt(6)
    v_mfma_f32_16x16x32_bf16 v[52:55], v[172:175], a[144:147], v[52:55]
    ds_read_b64_tr_b16 v[168:169], v8 offset:5216
    ds_read_b64_tr_b16 v[170:171], v8 offset:7776
    v_mfma_f32_16x16x32_bf16 v[56:59], v[172:175], a[148:151], v[56:59]
    v_mfma_f32_16x16x32_bf16 v[60:63], v[172:175], a[152:155], v[60:63]
    s_waitcnt lgkmcnt(6)
    v_mfma_f32_16x16x32_bf16 v[52:55], v[176:179], a[156:159], v[52:55]
    ds_read_b64_tr_b16 v[172:173], v8 offset:10336
    ds_read_b64_tr_b16 v[174:175], v8 offset:12896
    v_mfma_f32_16x16x32_bf16 v[56:59], v[176:179], a[160:163], v[56:59]
    v_mfma_f32_16x16x32_bf16 v[60:63], v[176:179], a[164:167], v[60:63]
    s_waitcnt lgkmcnt(6)
    v_mfma_f32_16x16x32_bf16 v[52:55], v[160:163], a[168:171], v[52:55]
    ds_read_b64_tr_b16 v[176:177], v8 offset:15456
    ds_read_b64_tr_b16 v[178:179], v8 offset:18016
    v_mfma_f32_16x16x32_bf16 v[56:59], v[160:163], a[172:175], v[56:59]
    v_mfma_f32_16x16x32_bf16 v[60:63], v[160:163], a[176:179], v[60:63]
    s_waitcnt lgkmcnt(6)
    v_mfma_f32_16x16x32_bf16 v[52:55], v[164:167], a[180:183], v[52:55]
    ds_read_b64_tr_b16 v[160:161], v8 offset:20576
    ds_read_b64_tr_b16 v[162:163], v8 offset:23136
    v_mfma_f32_16x16x32_bf16 v[56:59], v[164:167], a[184:187], v[56:59]
    v_mfma_f32_16x16x32_bf16 v[60:63], v[164:167], a[188:191], v[60:63]
    s_waitcnt lgkmcnt(6)
    v_mfma_f32_16x16x32_bf16 v[52:55], v[168:171], a[192:195], v[52:55]
    ds_read_b64_tr_b16 v[164:165], v8 offset:25696
    ds_read_b64_tr_b16 v[166:167], v8 offset:28256
    v_mfma_f32_16x16x32_bf16 v[56:59], v[168:171], a[196:199], v[56:59]
    v_mfma_f32_16x16x32_bf16 v[60:63], v[168:171], a[200:203], v[60:63]
    s_waitcnt lgkmcnt(6)
    v_mfma_f32_16x16x32_bf16 v[52:55], v[172:175], a[204:207], v[52:55]
    ds_read_b64_tr_b16 v[168:169], v8 offset:30816
    ds_read_b64_tr_b16 v[170:171], v8 offset:33376
    v_mfma_f32_16x16x32_bf16 v[56:59], v[172:175], a[208:211], v[56:59]
    v_mfma_f32_16x16x32_bf16 v[60:63], v[172:175], a[212:215], v[60:63]
    s_waitcnt lgkmcnt(6)
    v_mfma_f32_16x16x32_bf16 v[52:55], v[176:179], a[216:219], v[52:55]
    ds_read_b64_tr_b16 v[172:173], v8 offset:35936
    ds_read_b64_tr_b16 v[174:175], v8 offset:38496
    v_mfma_f32_16x16x32_bf16 v[56:59], v[176:179], a[220:223], v[56:59]
    v_mfma_f32_16x16x32_bf16 v[60:63], v[176:179], a[224:227], v[60:63]
    s_waitcnt lgkmcnt(6)
    v_mfma_f32_16x16x32_bf16 v[52:55], v[160:163], a[228:231], v[52:55]
    ds_read_b64_tr_b16 v[176:177], v8 offset:41056
    ds_read_b64_tr_b16 v[178:179], v8 offset:43616
    v_mfma_f32_16x16x32_bf16 v[56:59], v[160:163], a[232:235], v[56:59]
    v_mfma_f32_16x16x32_bf16 v[60:63], v[160:163], a[236:239], v[60:63]
    s_waitcnt lgkmcnt(6)
    v_mfma_f32_16x16x32_bf16 v[52:55], v[164:167], a[240:243], v[52:55]
    ds_read_b64_tr_b16 v[160:161], v8 offset:46176
    ds_read_b64_tr_b16 v[162:163], v8 offset:48736
    v_mfma_f32_16x16x32_bf16 v[56:59], v[164:167], a[244:247], v[56:59]
    v_mfma_f32_16x16x32_bf16 v[60:63], v[164:167], a[248:251], v[60:63]
    s_waitcnt lgkmcnt(6)
    v_mfma_f32_16x16x32_bf16 v[52:55], v[168:171], v[76:79], v[52:55]
    ds_read_b64_tr_b16 v[164:165], v8 offset:51296
    ds_read_b64_tr_b16 v[166:167], v8 offset:53856
    v_mfma_f32_16x16x32_bf16 v[56:59], v[168:171], v[80:83], v[56:59]
    v_mfma_f32_16x16x32_bf16 v[60:63], v[168:171], v[84:87], v[60:63]
    s_waitcnt lgkmcnt(6)
    v_mfma_f32_16x16x32_bf16 v[52:55], v[172:175], v[88:91], v[52:55]
    ds_read_b64_tr_b16 v[168:169], v8 offset:56416
    ds_read_b64_tr_b16 v[170:171], v8 offset:58976
    v_mfma_f32_16x16x32_bf16 v[56:59], v[172:175], v[92:95], v[56:59]
    v_mfma_f32_16x16x32_bf16 v[60:63], v[172:175], v[96:99], v[60:63]
    s_waitcnt lgkmcnt(6)
    v_mfma_f32_16x16x32_bf16 v[52:55], v[176:179], v[100:103], v[52:55]
    ds_read_b64_tr_b16 v[172:173], v10 offset:5216
    ds_read_b64_tr_b16 v[174:175], v10 offset:7776
    v_mfma_f32_16x16x32_bf16 v[56:59], v[176:179], v[104:107], v[56:59]
    v_mfma_f32_16x16x32_bf16 v[60:63], v[176:179], v[108:111], v[60:63]
    s_waitcnt lgkmcnt(6)
    v_mfma_f32_16x16x32_bf16 v[52:55], v[160:163], v[112:115], v[52:55]
    v_mfma_f32_16x16x32_bf16 v[56:59], v[160:163], v[116:119], v[56:59]
    v_mfma_f32_16x16x32_bf16 v[60:63], v[160:163], v[120:123], v[60:63]
    s_waitcnt lgkmcnt(4)
    v_mfma_f32_16x16x32_bf16 v[52:55], v[164:167], v[124:127], v[52:55]
    v_mfma_f32_16x16x32_bf16 v[56:59], v[164:167], v[128:131], v[56:59]
    v_mfma_f32_16x16x32_bf16 v[60:63], v[164:167], v[132:135], v[60:63]
    s_waitcnt lgkmcnt(2)
    v_mfma_f32_16x16x32_bf16 v[52:55], v[168:171], v[136:139], v[52:55]
    v_mfma_f32_16x16x32_bf16 v[56:59], v[168:171], v[140:143], v[56:59]
    v_mfma_f32_16x16x32_bf16 v[60:63], v[168:171], v[144:147], v[60:63]
    s_waitcnt lgkmcnt(0)
    v_mfma_f32_16x16x32_bf16 v[52:55], v[172:175], v[148:151], v[52:55]
    v_mfma_f32_16x16x32_bf16 v[56:59], v[172:175], v[152:155], v[56:59]
    v_mfma_f32_16x16x32_bf16 v[60:63], v[172:175], v[156:159], v[60:63]
    s_add_u32 s68, s65, 1
    s_and_b32 s68, s68, 3
    s_mul_i32 s68, s68, 12288
    s_add_u32 s68, s68, s77
    s_add_u32 s60, s65, 2
    s_and_b32 s60, s60, 3
    s_mul_i32 s60, s60, 12288
    s_add_u32 s60, s60, s77
    s_add_u32 s61, s65, 3
    s_and_b32 s61, s61, 3
    s_mul_i32 s61, s61, 12288
    s_add_u32 s61, s61, s77
    s_cmp_eq_u32 s65, 3
    s_cselect_b32 s63, 0, -1
    s_mov_b32 s67, 0
L_collect:
    buffer_load_dwordx4 v[76:79], v1, s[44:47], s68 offen offset:0 sc1
    buffer_load_dwordx4 v[80:83], v1, s[44:47], s68 offen offset:1024 sc1
    buffer_load_dwordx4 v[84:87], v1, s[44:47], s68 offen offset:2048 sc1
    buffer_load_dwordx4 v[88:91], v1, s[44:47], s60 offen offset:0 sc1
    buffer_load_dwordx4 v[92:95], v1, s[44:47], s60 offen offset:1024 sc1
    buffer_load_dwordx4 v[96:99], v1, s[44:47], s60 offen offset:2048 sc1
    buffer_load_dwordx4 v[100:103], v1, s[44:47], s61 offen offset:0 sc1
    buffer_load_dwordx4 v[104:107], v1, s[44:47], s61 offen offset:1024 sc1
    buffer_load_dwordx4 v[108:111], v1, s[44:47], s61 offen offset:2048 sc1
    s_cmp_lg_u32 s67, 0
    s_cbranch_scc1 L_col1
    s_mul_i32 s55, s53, 3
    s_add_u32 s55, s55, s3
    s_mul_i32 s55, s55, 61440
    s_mul_i32 s56, s66, 160
    s_add_u32 s55, s55, s56
    s_mul_i32 s56, s65, 20480
    s_add_u32 s56, s56, s55
    s_add_u32 s56, s56, 128
    s_cmp_eq_u32 s65, 3
    s_cselect_b32 s56, 0x7000000, s56
    s_lshl_b32 s57, s65, 5
    s_add_u32 s55, s55, s57
    s_cmp_lg_u32 s65, 1
    s_cbranch_scc1 L_own4_1
    v_mov_b64 v[64:65], v[68:69]
    v_mov_b64 v[66:67], v[70:71]
L_own4_1:
    s_cmp_lg_u32 s65, 2
    s_cbranch_scc1 L_own4_2
    v_mov_b64 v[64:65], v[72:73]
    v_mov_b64 v[66:67], v[74:75]
L_own4_2:
L_col1:
    s_waitcnt vmcnt(6)
    v_bitop3_b32 v2, v79, s100, 0 bitop3:0xbe
    v_bitop3_b32 v2, v83, s100, v2 bitop3:0xbe
    v_bitop3_b32 v3, v87, s100, 0 bitop3:0xbe
    s_waitcnt vmcnt(3)
    v_bitop3_b32 v2, v91, s100, v2 bitop3:0xbe
    v_bitop3_b32 v2, v95, s100, v2 bitop3:0xbe
    v_bitop3_b32 v3, v99, s100, v3 bitop3:0xbe
    s_waitcnt vmcnt(0)
    v_bitop3_b32 v2, v103, s100, v2 bitop3:0xbe
    v_bitop3_b32 v2, v107, s100, v2 bitop3:0xbe
    v_bitop3_b32 v3, v111, s100, v3 bitop3:0xbe
    v_and_or_b32 v2, v3, s63, v2
    v_cmp_ne_u32 vcc, 0, v2
    s_add_u32 s67, s67, 1
    s_cmp_ge_u32 s67, 0x40000
    s_cbranch_scc1 L_col2
    s_cbranch_vccz L_col2
    s_sleep 2
    s_branch L_collect
L_col2:
    s_mov_b32 s63, 0xffff0000
    v_lshlrev_b32 v112, 16, v76
    v_and_b32 v113, s63, v76
    v_lshlrev_b32 v114, 16, v77
    v_and_b32 v115, s63, v77
    v_lshlrev_b32 v116, 16, v88
    v_and_b32 v117, s63, v88
    v_lshlrev_b32 v118, 16, v89
    v_and_b32 v119, s63, v89
    v_lshlrev_b32 v120, 16, v100
    v_and_b32 v121, s63, v100
    v_lshlrev_b32 v122, 16, v101
    v_and_b32 v123, s63, v101
    v_pk_add_f32 v[52:53], v[52:53], v[112:113]
    v_pk_add_f32 v[116:117], v[116:117], v[120:121]
    v_pk_add_f32 v[54:55], v[54:55], v[114:115]
    v_pk_add_f32 v[118:119], v[118:119], v[122:123]
    v_pk_add_f32 v[52:53], v[52:53], v[116:117]
    v_pk_add_f32 v[54:55], v[54:55], v[118:119]
    v_cvt_pk_bf16_f32 v124, v52, v53
    v_cvt_pk_bf16_f32 v125, v54, v55
    buffer_store_dwordx2 v[124:125], v15, s[48:51], s55 offen
    s_add_u32 s55, s55, 20480
    v_lshlrev_b32 v112, 16, v78
    v_and_b32 v113, s63, v78
    v_lshlrev_b32 v114, 16, v80
    v_and_b32 v115, s63, v80
    v_lshlrev_b32 v116, 16, v90
    v_and_b32 v117, s63, v90
    v_lshlrev_b32 v118, 16, v92
    v_and_b32 v119, s63, v92
    v_lshlrev_b32 v120, 16, v102
    v_and_b32 v121, s63, v102
    v_lshlrev_b32 v122, 16, v104
    v_and_b32 v123, s63, v104
    v_pk_add_f32 v[56:57], v[56:57], v[112:113]
    v_pk_add_f32 v[116:117], v[116:117], v[120:121]
    v_pk_add_f32 v[58:59], v[58:59], v[114:115]
    v_pk_add_f32 v[118:119], v[118:119], v[122:123]
    v_pk_add_f32 v[56:57], v[56:57], v[116:117]
    v_pk_add_f32 v[58:59], v[58:59], v[118:119]
    v_cvt_pk_bf16_f32 v126, v56, v57
    v_cvt_pk_bf16_f32 v127, v58, v59
    buffer_store_dwordx2 v[126:127], v15, s[48:51], s55 offen
    s_add_u32 s55, s55, 20480
    v_lshlrev_b32 v112, 16, v81
    v_and_b32 v113, s63, v81
    v_lshlrev_b32 v114, 16, v82
    v_and_b32 v115, s63, v82
    v_lshlrev_b32 v116, 16, v93
    v_and_b32 v117, s63, v93
    v_lshlrev_b32 v118, 16, v94
    v_and_b32 v119, s63, v94
    v_lshlrev_b32 v120, 16, v105
    v_and_b32 v121, s63, v105
    v_lshlrev_b32 v122, 16, v106
    v_and_b32 v123, s63, v106
    v_pk_add_f32 v[60:61], v[60:61], v[112:113]
    v_pk_add_f32 v[116:117], v[116:117], v[120:121]
    v_pk_add_f32 v[62:63], v[62:63], v[114:115]
    v_pk_add_f32 v[118:119], v[118:119], v[122:123]
    v_pk_add_f32 v[60:61], v[60:61], v[116:117]
    v_pk_add_f32 v[62:63], v[62:63], v[118:119]
    v_cvt_pk_bf16_f32 v128, v60, v61
    v_cvt_pk_bf16_f32 v129, v62, v63
    buffer_store_dwordx2 v[128:129], v15, s[48:51], s55 offen
    v_lshlrev_b32 v112, 16, v84
    v_and_b32 v113, s63, v84
    v_lshlrev_b32 v114, 16, v85
    v_and_b32 v115, s63, v85
    v_lshlrev_b32 v116, 16, v96
    v_and_b32 v117, s63, v96
    v_lshlrev_b32 v118, 16, v97
    v_and_b32 v119, s63, v97
    v_lshlrev_b32 v120, 16, v108
    v_and_b32 v121, s63, v108
    v_lshlrev_b32 v122, 16, v109
    v_and_b32 v123, s63, v109
    v_pk_add_f32 v[64:65], v[64:65], v[112:113]
    v_pk_add_f32 v[116:117], v[116:117], v[120:121]
    v_pk_add_f32 v[66:67], v[66:67], v[114:115]
    v_pk_add_f32 v[118:119], v[118:119], v[122:123]
    v_pk_add_f32 v[64:65], v[64:65], v[116:117]
    v_pk_add_f32 v[66:67], v[66:67], v[118:119]
    v_cvt_pk_bf16_f32 v130, v64, v65
    v_cvt_pk_bf16_f32 v131, v66, v67
    buffer_store_dwordx2 v[130:131], v15, s[48:51], s56 offen
L_end:
    s_endpgm
L_stub0:
    s_call_b64 s[58:59], L_rare0
    s_branch L_ret0
L_stub1:
    s_call_b64 s[58:59], L_rare1
    s_branch L_ret1
L_stub2:
    s_call_b64 s[58:59], L_rare2
    s_branch L_ret2
L_stub3:
    s_call_b64 s[58:59], L_spin
    s_branch L_ret3
L_stub4:
    s_call_b64 s[58:59], L_rare0
    s_branch L_ret4
L_stub5:
    s_call_b64 s[58:59], L_rare1
    s_branch L_ret5
L_stub6:
    s_call_b64 s[58:59], L_rare2
    s_branch L_ret6
L_stub7:
    s_call_b64 s[58:59], L_spin
    s_branch L_ret7
L_stub8:
    s_call_b64 s[58:59], L_rare0
    s_branch L_ret8
L_stub9:
    s_call_b64 s[58:59], L_rare1
    s_branch L_ret9
L_stub10:
    s_call_b64 s[58:59], L_rare2
    s_branch L_ret10
L_stub11:
    s_call_b64 s[58:59], L_spin
    s_branch L_ret11
L_stub12:
    s_call_b64 s[58:59], L_rare0
    s_branch L_ret12
L_stub13:
    s_call_b64 s[58:59], L_rare1
    s_branch L_ret13
L_stub14:
    s_call_b64 s[58:59], L_rare2
    s_branch L_ret14
L_stub15:
    s_call_b64 s[58:59], L_spin
    s_branch L_ret15
L_stub16:
    s_call_b64 s[58:59], L_rare2
    s_branch L_ret16
L_stub17:
    s_call_b64 s[58:59], L_spin
    s_branch L_ret17
L_stub18:
    s_call_b64 s[58:59], L_spin
    s_branch L_ret18
L_stub19:
    s_call_b64 s[58:59], L_spin
    s_branch L_ret19
L_stub20:
    s_call_b64 s[58:59], L_spin
    s_branch L_ret20
L_spin:
    s_mov_b32 s67, 0
L_spin1:
    ds_read_b32 v5, v4
    s_add_u32 s67, s67, 1
    s_waitcnt lgkmcnt(0)
    v_cmp_gt_u32 vcc, s62, v5
    s_cmp_ge_u32 s67, 1048576
    s_cbranch_scc1 L_spin2
    s_cbranch_vccz L_spin2
    s_sleep 2
    s_branch L_spin1
L_spin2:
    s_setpc_b64 s[58:59]
L_rare0:
    s_nop 7
    v_max3_f32 v1, v136, v137, v138
    v_max3_f32 v1, v1, v139, v140
    v_max3_f32 v1, v1, v141, v142
    v_max_f32 v1, v1, v143
    v_mov_b32 v2, v1
    s_nop 1
    v_permlane16_swap_b32 v1, v2
    v_max_f32 v1, v1, v2
    v_mov_b32 v2, v1
    s_nop 1
    v_permlane32_swap_b32 v1, v2
    v_max_f32 v1, v1, v2
    v_add_f32 v1, 0x40e00000, v1
    v_max_f32 v1, 0, v1
    v_exp_f32 v2, -v1
    v_exp_f32 v3, -v1
    s_nop 0
    v_pk_mul_f32 v[16:17], v[16:17], v[2:3]
    v_pk_mul_f32 v[18:19], v[18:19], v[2:3]
    v_pk_mul_f32 v[20:21], v[20:21], v[2:3]
    v_pk_mul_f32 v[22:23], v[22:23], v[2:3]
    v_pk_mul_f32 v[24:25], v[24:25], v[2:3]
    v_pk_mul_f32 v[26:27], v[26:27], v[2:3]
    v_pk_mul_f32 v[28:29], v[28:29], v[2:3]
    v_pk_mul_f32 v[30:31], v[30:31], v[2:3]
    v_pk_mul_f32 v[32:33], v[32:33], v[2:3]
    v_pk_mul_f32 v[34:35], v[34:35], v[2:3]
    v_pk_mul_f32 v[36:37], v[36:37], v[2:3]
    v_pk_mul_f32 v[38:39], v[38:39], v[2:3]
    v_pk_mul_f32 v[40:41], v[40:41], v[2:3]
    v_pk_mul_f32 v[42:43], v[42:43], v[2:3]
    v_pk_mul_f32 v[44:45], v[44:45], v[2:3]
    v_pk_mul_f32 v[46:47], v[46:47], v[2:3]
    v_pk_mul_f32 v[112:113], v[112:113], v[2:3]
    v_pk_mul_f32 v[114:115], v[114:115], v[2:3]
    v_sub_f32 v124, v124, v1
    v_sub_f32 v125, v125, v1
    v_sub_f32 v126, v126, v1
    v_sub_f32 v127, v127, v1
    v_sub_f32 v136, v136, v1
    v_sub_f32 v137, v137, v1
    v_sub_f32 v138, v138, v1
    v_sub_f32 v139, v139, v1
    v_sub_f32 v140, v140, v1
    v_sub_f32 v141, v141, v1
    v_sub_f32 v142, v142, v1
    v_sub_f32 v143, v143, v1
    v_exp_f32 v136, v136
    v_exp_f32 v137, v137
    v_exp_f32 v138, v138
    v_exp_f32 v139, v139
    v_exp_f32 v140, v140
    v_exp_f32 v141, v141
    v_exp_f32 v142, v142
    v_exp_f32 v143, v143
    s_nop 0
    v_cvt_pk_bf16_f32 v168, v136, v137
    v_cvt_pk_bf16_f32 v169, v138, v139
    v_cvt_pk_bf16_f32 v170, v140, v141
    v_cvt_pk_bf16_f32 v171, v142, v143
    s_nop 1
    s_setpc_b64 s[58:59]
L_rare1:
    s_nop 7
    v_max3_f32 v1, v144, v145, v146
    v_max3_f32 v1, v1, v147, v148
    v_max3_f32 v1, v1, v149, v150
    v_max_f32 v1, v1, v151
    v_mov_b32 v2, v1
    s_nop 1
    v_permlane16_swap_b32 v1, v2
    v_max_f32 v1, v1, v2
    v_mov_b32 v2, v1
    s_nop 1
    v_permlane32_swap_b32 v1, v2
    v_max_f32 v1, v1, v2
    v_add_f32 v1, 0x40e00000, v1
    v_max_f32 v1, 0, v1
    v_exp_f32 v2, -v1
    v_exp_f32 v3, -v1
    s_nop 0
    v_pk_mul_f32 v[48:49], v[48:49], v[2:3]
    v_pk_mul_f32 v[50:51], v[50:51], v[2:3]
    v_pk_mul_f32 v[52:53], v[52:53], v[2:3]
    v_pk_mul_f32 v[54:55], v[54:55], v[2:3]
    v_pk_mul_f32 v[56:57], v[56:57], v[2:3]
    v_pk_mul_f32 v[58:59], v[58:59], v[2:3]
    v_pk_mul_f32 v[60:61], v[60:61], v[2:3]
    v_pk_mul_f32 v[62:63], v[62:63], v[2:3]
    v_pk_mul_f32 v[64:65], v[64:65], v[2:3]
    v_pk_mul_f32 v[66:67], v[66:67], v[2:3]
    v_pk_mul_f32 v[68:69], v[68:69], v[2:3]
    v_pk_mul_f32 v[70:71], v[70:71], v[2:3]
    v_pk_mul_f32 v[72:73], v[72:73], v[2:3]
    v_pk_mul_f32 v[74:75], v[74:75], v[2:3]
    v_pk_mul_f32 v[76:77], v[76:77], v[2:3]
    v_pk_mul_f32 v[78:79], v[78:79], v[2:3]
    v_pk_mul_f32 v[116:117], v[116:117], v[2:3]
    v_pk_mul_f32 v[118:119], v[118:119], v[2:3]
    v_sub_f32 v128, v128, v1
    v_sub_f32 v129, v129, v1
    v_sub_f32 v130, v130, v1
    v_sub_f32 v131, v131, v1
    v_sub_f32 v144, v144, v1
    v_sub_f32 v145, v145, v1
    v_sub_f32 v146, v146, v1
    v_sub_f32 v147, v147, v1
    v_sub_f32 v148, v148, v1
    v_sub_f32 v149, v149, v1
    v_sub_f32 v150, v150, v1
    v_sub_f32 v151, v151, v1
    v_exp_f32 v144, v144
    v_exp_f32 v145, v145
    v_exp_f32 v146, v146
    v_exp_f32 v147, v147
    v_exp_f32 v148, v148
    v_exp_f32 v149, v149
    v_exp_f32 v150, v150
    v_exp_f32 v151, v151
    s_nop 0
    v_cvt_pk_bf16_f32 v172, v144, v145
    v_cvt_pk_bf16_f32 v173, v146, v147
    v_cvt_pk_bf16_f32 v174, v148, v149
    v_cvt_pk_bf16_f32 v175, v150, v151
    s_nop 1
    s_setpc_b64 s[58:59]
L_rare2:
    s_nop 7
    v_max3_f32 v1, v152, v153, v154
    v_max3_f32 v1, v1, v155, v156
    v_max3_f32 v1, v1, v157, v158
    v_max_f32 v1, v1, v159
    v_mov_b32 v2, v1
    s_nop 1
    v_permlane16_swap_b32 v1, v2
    v_max_f32 v1, v1, v2
    v_mov_b32 v2, v1
    s_nop 1
    v_permlane32_swap_b32 v1, v2
    v_max_f32 v1, v1, v2
    v_add_f32 v1, 0x40e00000, v1
    v_max_f32 v1, 0, v1
    v_exp_f32 v2, -v1
    v_exp_f32 v3, -v1
    s_nop 0
    v_pk_mul_f32 v[80:81], v[80:81], v[2:3]
    v_pk_mul_f32 v[82:83], v[82:83], v[2:3]
    v_pk_mul_f32 v[84:85], v[84:85], v[2:3]
    v_pk_mul_f32 v[86:87], v[86:87], v[2:3]
    v_pk_mul_f32 v[88:89], v[88:89], v[2:3]
    v_pk_mul_f32 v[90:91], v[90:91], v[2:3]
    v_pk_mul_f32 v[92:93], v[92:93], v[2:3]
    v_pk_mul_f32 v[94:95], v[94:95], v[2:3]
    v_pk_mul_f32 v[96:97], v[96:97], v[2:3]
    v_pk_mul_f32 v[98:99], v[98:99], v[2:3]
    v_pk_mul_f32 v[100:101], v[100:101], v[2:3]
    v_pk_mul_f32 v[102:103], v[102:103], v[2:3]
    v_pk_mul_f32 v[104:105], v[104:105], v[2:3]
    v_pk_mul_f32 v[106:107], v[106:107], v[2:3]
    v_pk_mul_f32 v[108:109], v[108:109], v[2:3]
    v_pk_mul_f32 v[110:111], v[110:111], v[2:3]
    v_pk_mul_f32 v[120:121], v[120:121], v[2:3]
    v_pk_mul_f32 v[122:123], v[122:123], v[2:3]
    v_sub_f32 v132, v132, v1
    v_sub_f32 v133, v133, v1
    v_sub_f32 v134, v134, v1
    v_sub_f32 v135, v135, v1
    v_sub_f32 v152, v152, v1
    v_sub_f32 v153, v153, v1
    v_sub_f32 v154, v154, v1
    v_sub_f32 v155, v155, v1
    v_sub_f32 v156, v156, v1
    v_sub_f32 v157, v157, v1
    v_sub_f32 v158, v158, v1
    v_sub_f32 v159, v159, v1
    v_exp_f32 v152, v152
    v_exp_f32 v153, v153
    v_exp_f32 v154, v154
    v_exp_f32 v155, v155
    v_exp_f32 v156, v156
    v_exp_f32 v157, v157
    v_exp_f32 v158, v158
    v_exp_f32 v159, v159
    s_nop 0
    v_cvt_pk_bf16_f32 v176, v152, v153
    v_cvt_pk_bf16_f32 v177, v154, v155
    v_cvt_pk_bf16_f32 v178, v156, v157
    v_cvt_pk_bf16_f32 v179, v158, v159
    s_nop 1
    s_setpc_b64 s[58:59]
L_code_end:

.section .rodata,"a"
.p2align 6
.amdhsa_kernel standalone__mha_block_cached__near_ridge_kernel
  .amdhsa_next_free_vgpr 512
  .amdhsa_next_free_sgpr 102
  .amdhsa_accum_offset 256
  .amdhsa_group_segment_fixed_size 0
  .amdhsa_kernarg_size 64
  .amdhsa_user_sgpr_count 2
  .amdhsa_user_sgpr_kernarg_segment_ptr 1
  .amdhsa_system_sgpr_workgroup_id_x 1
  .amdhsa_float_denorm_mode_32 3
.end_amdhsa_kernel
```
